```python
import torch

def _softmax(x, axis=-1):
    return torch.softmax(x, dim=axis)
def _gelu(x):
    return torch.nn.functional.gelu(x, approximate="tanh")
def _silu(x):
    return torch.nn.functional.silu(x)
def _sigmoid(x):
    return torch.sigmoid(x)
def _layernorm(x, axis=-1, eps=1e-5):
    m = x.mean(dim=axis, keepdim=True)
    v = x.var(dim=axis, keepdim=True, unbiased=False)
    return (x - m) / torch.sqrt(v + eps)
def _scatter_add(tgt, idx, src, axis=0):
    return tgt.clone().index_add_(axis, idx, src)
def _segment_sum(src, seg, n):
    out = torch.zeros((n,) + src.shape[1:], dtype=src.dtype)
    return out.index_add_(0, seg, src)
def _pad(x, pw):
    flat = tuple(v for pair in reversed(pw) for v in pair)
    return torch.nn.functional.pad(x, flat)

kernel_name = 'sequential_preLN__spectral_gfnet__glu_gated_bilinear__prompt'

def setup_inputs():

    _w = (lambda a: (lambda t: t.to(torch.bfloat16) if t.is_floating_point() else t)(torch.as_tensor(a)))
    def _A_setup():
        B, S, D = 1, 2048, 448
        Df = D // 2 + 1
        return {
            "x": _w((lambda *s: torch.randn(*s, dtype=torch.bfloat16) * 0.05)(B, S, D)),
            "w_r": _w((lambda *s: torch.randn(*s, dtype=torch.bfloat16) * 0.4)(S, Df) * 0.02),
            "w_i": _w((lambda *s: torch.randn(*s, dtype=torch.bfloat16) * 0.4)(S, Df) * 0.02),
        }
    _A_in = _A_setup()

    def _B_setup():
        B, S, D, F = 1, 2048, 448, 1792
        return {
            "x": _w((lambda *s: torch.randn(*s, dtype=torch.bfloat16) * 0.05)(B, S, D)),
            "w_gate": _w((lambda *s: torch.randn(*s, dtype=torch.bfloat16) * 0.2)(D, F) * (D ** -0.5)),
            "w_up": _w((lambda *s: torch.randn(*s, dtype=torch.bfloat16) * 0.2)(D, F) * (D ** -0.5)),
            "w_down": _w((lambda *s: torch.randn(*s, dtype=torch.bfloat16) * 0.2)(F, D) * (F ** -0.5)),
        }
    _B_in = _B_setup()

    return {
        "A_x": _A_in["x"],
        "A_w_r": _A_in["w_r"],
        "A_w_i": _A_in["w_i"],
        "B_x": _B_in["x"],
        "B_w_gate": _B_in["w_gate"],
        "B_w_up": _B_in["w_up"],
        "B_w_down": _B_in["w_down"],
    }

def reference(A_x, A_w_r, A_w_i, B_x, B_w_gate, B_w_up, B_w_down):
    def _A_ref(x, w_r, w_i):
        B, S, D = x.shape
        X = (lambda x, axes=(-2,-1): torch.fft.rfft2(x.float(), dim=axes))(x, axes=(-2, -1))
        W = w_r + 1j * w_i
        X = X * W
        y = (lambda x, s, axes=(-2,-1): torch.fft.irfft2(x, s=s, dim=axes).to(torch.bfloat16))(X, (S, D), axes=(-2, -1))
        return y

    def _B_ref(x, w_gate, w_up, w_down):
        g = torch.einsum("bsd,df->bsf", x, w_gate)
        u = torch.einsum("bsd,df->bsf", x, w_up)
        h = g * u
        return torch.einsum("bsf,fd->bsd", h, w_down)

    x = A_x
    h = x + _A_ref(_layernorm(x, axis=-1), A_w_r, A_w_i)
    h2 = h + _B_ref(_layernorm(h, axis=-1), B_w_gate, B_w_up, B_w_down)
    return h2
```

```asm
; @launch grid=(256,1,1) block=(256,1,1) lds=156672
.amdgcn_target "amdgcn-amd-amdhsa--gfx950"
.text
.globl sequential_preLN__spectral_gfnet__glu_gated_bilinear__prompt_kernel
.p2align 8
.type sequential_preLN__spectral_gfnet__glu_gated_bilinear__prompt_kernel,@function
sequential_preLN__spectral_gfnet__glu_gated_bilinear__prompt_kernel:
    s_load_dwordx2 s[4:5], s[0:1], 0
    s_load_dwordx4 s[44:47], s[0:1], 8
    s_load_dwordx4 s[52:55], s[0:1], 32
    s_load_dwordx4 s[56:59], s[0:1], 48
    s_load_dwordx2 s[62:63], s[0:1], 64
    s_load_dwordx2 s[6:7], s[0:1], 72
    s_and_b32 s3, s2, 0xffffffe0
    s_cmp_lg_u32 s3, 224
    s_cbranch_scc1 L_se_noc_4
    s_getpc_b64 s[8:9]
L_se_pc_3:
    s_bfe_u32 s3, s2, 0x20003
    v_lshrrev_b32 v1, 2, v0
    s_lshl_b32 s3, s3, 13
    v_lshl_add_u32 v1, v1, 7, s3
    v_mov_b32 v3, s9
    v_add_co_u32 v2, vcc, s8, v1
    s_nop 1
    v_addc_co_u32 v3, vcc, 0, v3, vcc
    global_load_dword v113, v[2:3], off
L_se_noc_4:
    s_cmp_ge_u32 s2, 256
    s_cbranch_scc1 L_se_end_1
    v_lshrrev_b32 v2, 6, v0
    v_and_b32 v1, 63, v0
    v_readfirstlane_b32 s20, v2
    s_cmp_ge_u32 s2, 224
    s_cbranch_scc1 L_se_spare_2
    s_lshr_b32 s26, s2, 3
    s_mul_i32 s27, s26, 37
    s_lshr_b32 s27, s27, 8
    s_and_b32 s28, s2, 7
    s_lshl2_add_u32 s24, s28, s27
    s_mul_i32 s28, s27, 7
    s_sub_u32 s22, s26, s28
    v_lshrrev_b32 v4, 5, v1
    v_bfe_u32 v5, v1, 3, 2
    v_lshl_add_u32 v4, v4, 4, v5
    v_mul_u32_u24 v4, 0x7000, v4
    v_lshrrev_b32 v5, 4, v1
    v_and_b32 v6, 7, v1
    v_xor_b32 v6, v6, v5
    v_lshl_add_u32 v2, v6, 4, v4
    v_xor_b32 v3, 64, v2
    v_add_u32 v3, 917504, v3
    s_lshl_b32 s26, s20, 7
    s_add_u32 s26, s26, s24
    s_mul_i32 s26, s26, 896
    s_lshl_b32 s27, s20, 11
    s_waitcnt lgkmcnt(0)
    s_mov_b32 s12, s4
    s_and_b32 s13, s5, 0xffff
    s_mov_b32 s14, 1835008
    s_mov_b32 s15, 0x20000
    s_mov_b32 s48, s22
    s_lshl_b32 s49, s48, 7
    s_add_u32 s49, s49, s26
    s_lshl_b32 s51, s48, 13
    s_add_u32 m0, s51, s27
    s_nop 0
    buffer_load_dwordx4 v2, s[12:15], s49 offen lds
    v_and_b32 v8, 15, v1
    s_and_b32 s28, s20, 1
    s_lshl_b32 s28, s28, 4
    s_lshl_b32 s29, s22, 5
    s_add_u32 s28, s28, s29
    v_add_u32 v27, s28, v8
    v_lshrrev_b32 v9, 1, v8
    v_xor_b32 v9, v9, v5
    v_lshlrev_b32 v9, 4, v9
    v_lshl_add_u32 v4, v8, 7, v9
    v_add_u32 v19, 1, v27
    v_cvt_f32_u32 v20, v19
    v_and_b32 v19, 1, v19
    v_lshlrev_b32 v19, 31, v19
    v_or_b32 v17, 1.0, v19
    v_mul_f32 v10, 0x3b124925, v20
    s_add_u32 m0, m0, 1024
    s_nop 0
    buffer_load_dwordx4 v3, s[12:15], s49 offen lds
    v_mul_f32 v11, 0x3b924925, v20
    v_mul_f32 v12, 0x3bdb6db7, v20
    v_mul_f32 v13, 0x3c124925, v20
    v_mul_f32 v14, 0x3c36db6e, v20
    v_mul_f32 v15, 0x3c5b6db7, v20
    v_mul_f32 v16, 0x3c800000, v20
    v_mul_f32 v9, 0x3d924925, v20
    v_fract_f32 v9, v9
    v_lshlrev_b32 v21, 3, v5
    v_cvt_f32_u32 v21, v21
    s_lshr_b32 s30, s20, 1
    s_mul_i32 s31, s30, 0x3e800000
    v_mov_b32 v8, s31
    v_fmac_f32 v8, v21, v10
    v_fract_f32 v8, v8
    s_and_b32 s23, s24, 1
    s_add_u32 s48, s48, 1
    s_cmp_eq_u32 s48, 7
    s_cselect_b32 s48, 0, s48
    s_lshl_b32 s49, s48, 7
    s_add_u32 s49, s49, s26
    s_lshl_b32 s51, s48, 13
    s_add_u32 m0, s51, s27
    s_nop 0
    buffer_load_dwordx4 v2, s[12:15], s49 offen lds
    s_lshr_b32 s21, s24, 1
    s_mul_i32 s25, s23, 7
    s_add_u32 s25, s25, s22
    s_lshl_b32 s32, s25, 8
    s_mul_i32 s35, s20, 14336
    s_add_u32 s32, s32, s35
    s_lshl2_add_u32 s25, s25, s20
    s_add_u32 s38, s32, 1605632
    s_and_b32 s3, s2, 7
    s_min_u32 s3, s3, 0
    s_mul_i32 s35, s3, 229376
    s_add_u32 s32, s32, s35
    s_lshl_b32 s3, s3, 12
    v_bfe_u32 v21, v1, 2, 2
    v_xor_b32 v22, v21, v5
    v_and_b32 v23, 3, v1
    s_add_u32 m0, m0, 1024
    s_nop 0
    buffer_load_dwordx4 v3, s[12:15], s49 offen lds
    v_lshlrev_b32 v22, 6, v22
    v_lshl_add_u32 v22, v23, 4, v22
    v_mul_u32_u24 v250, 0xe00, v5
    v_add_u32 v250, v250, v22
    v_xor_b32 v22, s20, v21
    v_lshlrev_b32 v22, 6, v22
    v_lshl_add_u32 v22, v21, 8, v22
    v_lshl_add_u32 v22, v23, 3, v22
    v_and_b32 v23, 1, v5
    v_lshl_add_u32 v22, v23, 5, v22
    v_lshrrev_b32 v23, 5, v1
    v_lshl_add_u32 v22, v23, 11, v22
    v_add_u32 v251, 57344, v22
    v_add_u32 v252, 123904, v22
    s_lshl_b32 s35, s20, 10
    v_xor_b32 v5, 64, v4
    s_add_u32 s48, s48, 1
    s_cmp_eq_u32 s48, 7
    s_cselect_b32 s48, 0, s48
    s_lshl_b32 s49, s48, 7
    s_add_u32 s49, s49, s26
    s_lshl_b32 s51, s48, 13
    s_add_u32 m0, s51, s27
    s_nop 0
    buffer_load_dwordx4 v2, s[12:15], s49 offen lds
    v_add_u32 v6, s27, v4
    v_add_u32 v7, s27, v5
    v_mov_b32 v152, 0x3f803f80
    v_mov_b32 v153, 0x3f803f80
    v_mov_b32 v154, 0x3f803f80
    v_mov_b32 v155, 0x3f803f80
    v_cos_f32 v19, v8
    v_add_f32 v20, v8, v10
    v_add_f32 v21, v8, v11
    v_add_f32 v22, v8, v12
    v_add_f32 v23, v8, v13
    v_add_f32 v24, v8, v14
    v_add_f32 v25, v8, v15
    v_add_f32 v26, v8, v16
    v_cos_f32 v20, v20
    v_cos_f32 v21, v21
    s_add_u32 m0, m0, 1024
    s_nop 0
    buffer_load_dwordx4 v3, s[12:15], s49 offen lds
    v_cos_f32 v22, v22
    v_cos_f32 v23, v23
    v_cos_f32 v24, v24
    v_cos_f32 v25, v25
    v_cos_f32 v26, v26
    v_add_f32 v8, v8, v9
    v_fract_f32 v8, v8
    v_cvt_pk_bf16_f32 v28, v19, v20
    v_cvt_pk_bf16_f32 v29, v21, v22
    v_cvt_pk_bf16_f32 v30, v23, v24
    v_cvt_pk_bf16_f32 v31, v25, v26
    v_cos_f32 v19, v8
    v_add_f32 v20, v8, v10
    v_add_f32 v21, v8, v11
    v_add_f32 v22, v8, v12
    v_add_f32 v23, v8, v13
    s_add_u32 s48, s48, 1
    s_cmp_eq_u32 s48, 7
    s_cselect_b32 s48, 0, s48
    s_lshl_b32 s49, s48, 7
    s_add_u32 s49, s49, s26
    s_lshl_b32 s51, s48, 13
    s_add_u32 m0, s51, s27
    s_nop 0
    buffer_load_dwordx4 v2, s[12:15], s49 offen lds
    v_add_f32 v24, v8, v14
    v_add_f32 v25, v8, v15
    v_add_f32 v26, v8, v16
    v_cos_f32 v20, v20
    v_cos_f32 v21, v21
    v_cos_f32 v22, v22
    v_cos_f32 v23, v23
    v_cos_f32 v24, v24
    v_cos_f32 v25, v25
    v_cos_f32 v26, v26
    v_add_f32 v8, v8, v9
    v_fract_f32 v8, v8
    v_cvt_pk_bf16_f32 v32, v19, v20
    v_cvt_pk_bf16_f32 v33, v21, v22
    v_cvt_pk_bf16_f32 v34, v23, v24
    v_cvt_pk_bf16_f32 v35, v25, v26
    s_add_u32 m0, m0, 1024
    s_nop 0
    buffer_load_dwordx4 v3, s[12:15], s49 offen lds
    v_mfma_f32_16x16x32_bf16 v[156:159], v[152:155], v[28:31], 0
    v_cos_f32 v19, v8
    v_add_f32 v20, v8, v10
    v_add_f32 v21, v8, v11
    v_add_f32 v22, v8, v12
    v_add_f32 v23, v8, v13
    v_add_f32 v24, v8, v14
    v_add_f32 v25, v8, v15
    v_add_f32 v26, v8, v16
    v_cos_f32 v20, v20
    v_cos_f32 v21, v21
    v_cos_f32 v22, v22
    v_cos_f32 v23, v23
    v_cos_f32 v24, v24
    v_cos_f32 v25, v25
    v_cos_f32 v26, v26
    s_add_u32 s48, s48, 1
    s_cmp_eq_u32 s48, 7
    s_cselect_b32 s48, 0, s48
    s_lshl_b32 s49, s48, 7
    s_add_u32 s49, s49, s26
    s_lshl_b32 s51, s48, 13
    s_add_u32 m0, s51, s27
    s_nop 0
    buffer_load_dwordx4 v2, s[12:15], s49 offen lds
    v_add_f32 v8, v8, v9
    v_fract_f32 v8, v8
    v_cvt_pk_bf16_f32 v36, v19, v20
    v_cvt_pk_bf16_f32 v37, v21, v22
    v_cvt_pk_bf16_f32 v38, v23, v24
    v_cvt_pk_bf16_f32 v39, v25, v26
    v_mfma_f32_16x16x32_bf16 v[156:159], v[152:155], v[32:35], v[156:159]
    v_cos_f32 v19, v8
    v_add_f32 v20, v8, v10
    v_add_f32 v21, v8, v11
    v_add_f32 v22, v8, v12
    v_add_f32 v23, v8, v13
    v_add_f32 v24, v8, v14
    v_add_f32 v25, v8, v15
    v_add_f32 v26, v8, v16
    v_cos_f32 v20, v20
    s_add_u32 m0, m0, 1024
    s_nop 0
    buffer_load_dwordx4 v3, s[12:15], s49 offen lds
    v_cos_f32 v21, v21
    v_cos_f32 v22, v22
    v_cos_f32 v23, v23
    v_cos_f32 v24, v24
    v_cos_f32 v25, v25
    v_cos_f32 v26, v26
    v_add_f32 v8, v8, v9
    v_fract_f32 v8, v8
    v_cvt_pk_bf16_f32 v40, v19, v20
    v_cvt_pk_bf16_f32 v41, v21, v22
    v_cvt_pk_bf16_f32 v42, v23, v24
    v_cvt_pk_bf16_f32 v43, v25, v26
    v_mfma_f32_16x16x32_bf16 v[156:159], v[152:155], v[36:39], v[156:159]
    v_cos_f32 v19, v8
    v_add_f32 v20, v8, v10
    v_add_f32 v21, v8, v11
    s_add_u32 s48, s48, 1
    s_cmp_eq_u32 s48, 7
    s_cselect_b32 s48, 0, s48
    s_lshl_b32 s49, s48, 7
    s_add_u32 s49, s49, s26
    s_lshl_b32 s51, s48, 13
    s_add_u32 m0, s51, s27
    s_nop 0
    buffer_load_dwordx4 v2, s[12:15], s49 offen lds
    v_add_f32 v22, v8, v12
    v_add_f32 v23, v8, v13
    v_add_f32 v24, v8, v14
    v_add_f32 v25, v8, v15
    v_add_f32 v26, v8, v16
    v_cos_f32 v20, v20
    v_cos_f32 v21, v21
    v_cos_f32 v22, v22
    v_cos_f32 v23, v23
    v_cos_f32 v24, v24
    v_cos_f32 v25, v25
    v_cos_f32 v26, v26
    v_add_f32 v8, v8, v9
    v_fract_f32 v8, v8
    v_cvt_pk_bf16_f32 v44, v19, v20
    v_cvt_pk_bf16_f32 v45, v21, v22
    s_add_u32 m0, m0, 1024
    s_nop 0
    buffer_load_dwordx4 v3, s[12:15], s49 offen lds
    v_cvt_pk_bf16_f32 v46, v23, v24
    v_cvt_pk_bf16_f32 v47, v25, v26
    v_mfma_f32_16x16x32_bf16 v[156:159], v[152:155], v[40:43], v[156:159]
    v_cos_f32 v19, v8
    v_add_f32 v20, v8, v10
    v_add_f32 v21, v8, v11
    v_add_f32 v22, v8, v12
    v_add_f32 v23, v8, v13
    v_add_f32 v24, v8, v14
    v_add_f32 v25, v8, v15
    v_add_f32 v26, v8, v16
    v_cos_f32 v20, v20
    v_cos_f32 v21, v21
    v_cos_f32 v22, v22
    v_cos_f32 v23, v23
    v_cos_f32 v24, v24
    s_add_u32 s48, s48, 1
    s_cmp_eq_u32 s48, 7
    s_cselect_b32 s48, 0, s48
    s_lshl_b32 s49, s48, 7
    s_add_u32 s49, s49, s26
    s_lshl_b32 s51, s48, 13
    s_add_u32 m0, s51, s27
    s_nop 0
    buffer_load_dwordx4 v2, s[12:15], s49 offen lds
    v_cos_f32 v25, v25
    v_cos_f32 v26, v26
    v_add_f32 v8, v8, v9
    v_fract_f32 v8, v8
    v_cvt_pk_bf16_f32 v48, v19, v20
    v_cvt_pk_bf16_f32 v49, v21, v22
    v_cvt_pk_bf16_f32 v50, v23, v24
    v_cvt_pk_bf16_f32 v51, v25, v26
    v_mfma_f32_16x16x32_bf16 v[156:159], v[152:155], v[44:47], v[156:159]
    v_cos_f32 v19, v8
    v_add_f32 v20, v8, v10
    v_add_f32 v21, v8, v11
    v_add_f32 v22, v8, v12
    v_add_f32 v23, v8, v13
    v_add_f32 v24, v8, v14
    v_add_f32 v25, v8, v15
    s_add_u32 m0, m0, 1024
    s_nop 0
    buffer_load_dwordx4 v3, s[12:15], s49 offen lds
    v_add_f32 v26, v8, v16
    v_cos_f32 v20, v20
    v_cos_f32 v21, v21
    v_cos_f32 v22, v22
    v_cos_f32 v23, v23
    v_cos_f32 v24, v24
    v_cos_f32 v25, v25
    v_cos_f32 v26, v26
    v_cvt_pk_bf16_f32 v52, v19, v20
    v_cvt_pk_bf16_f32 v53, v21, v22
    v_cvt_pk_bf16_f32 v54, v23, v24
    v_cvt_pk_bf16_f32 v55, v25, v26
    v_mfma_f32_16x16x32_bf16 v[156:159], v[152:155], v[48:51], v[156:159]
    s_mov_b32 s8, s46
    s_and_b32 s9, s47, 0xffff
    s_mov_b32 s10, 921600
    s_mov_b32 s11, 0x20000
    s_and_b32 s45, s45, 0xffff
    s_mov_b32 s46, 921600
    s_mov_b32 s47, 0x20000
    s_and_b32 s50, s24, 28
    s_add_u32 s50, s50, s20
    s_and_b32 s36, s24, 3
    s_lshl2_add_u32 s50, s50, s36
    s_mul_i32 s50, s50, 7200
    s_lshl_b32 s36, s22, 6
    s_add_u32 s50, s50, s36
    s_add_u32 s50, s50, 2
    v_lshrrev_b32 v230, 2, v1
    v_and_b32 v231, 3, v1
    v_mul_u32_u24 v232, 0x1c2, v230
    v_lshl_add_u32 v232, v231, 4, v232
    buffer_load_dwordx4 v[160:163], v232, s[44:47], s50 offen
    buffer_load_dwordx4 v[164:167], v232, s[8:11], s50 offen
    v_lshlrev_b32 v230, 4, v230
    v_lshl_add_u32 v230, v231, 11, v230
    s_lshl2_add_u32 s50, s20, 114688
    v_add_u32 v230, s50, v230
    s_mov_b32 s8, s6
    s_and_b32 s9, s7, 0xffff
    s_mov_b32 s10, 11665408
    s_mov_b32 s11, 0x20000
    s_mov_b32 s40, s52
    s_and_b32 s41, s53, 0xffff
    s_mov_b32 s42, 1605632
    s_mov_b32 s43, 0x20000
    s_mov_b32 s44, s54
    s_and_b32 s45, s55, 0xffff
    s_mov_b32 s46, 1605632
    s_mov_b32 s47, 0x20000
    s_mov_b32 s16, s58
    s_and_b32 s17, s59, 0xffff
    s_mov_b32 s18, 1835008
    s_mov_b32 s19, 0x20000
    s_mov_b32 s48, s56
    s_mov_b32 s49, s57
    v_mfma_f32_16x16x32_bf16 v[156:159], v[152:155], v[52:55], v[156:159]
    s_lshl_b32 s51, s22, 13
    v_add_u32 v26, s51, v6
    v_add_u32 v18, s51, v7
    s_add_u32 s51, s51, 8192
    s_cmp_eq_u32 s51, 57344
    s_cselect_b32 s51, 0, s51
    s_waitcnt vmcnt(14)
    ds_read_b128 v[56:59], v26
    ds_read_b128 v[60:63], v18
    v_add_u32 v26, s51, v6
    v_add_u32 v18, s51, v7
    s_add_u32 s51, s51, 8192
    s_cmp_eq_u32 s51, 57344
    s_cselect_b32 s51, 0, s51
    s_waitcnt vmcnt(12)
    ds_read_b128 v[64:67], v26
    ds_read_b128 v[68:71], v18
    s_waitcnt lgkmcnt(2)
    v_mfma_f32_16x16x32_bf16 v[20:23], v[56:59], v[152:155], 0
    v_mfma_f32_16x16x32_bf16 v[120:123], v[56:59], v[56:59], 0
    v_mfma_f32_16x16x32_bf16 v[20:23], v[60:63], v[152:155], v[20:23]
    v_mfma_f32_16x16x32_bf16 v[120:123], v[60:63], v[60:63], v[120:123]
    v_add_u32 v26, s51, v6
    v_add_u32 v18, s51, v7
    s_add_u32 s51, s51, 8192
    s_cmp_eq_u32 s51, 57344
    s_cselect_b32 s51, 0, s51
    s_waitcnt vmcnt(10)
    ds_read_b128 v[56:59], v26
    ds_read_b128 v[60:63], v18
    s_waitcnt lgkmcnt(2)
    v_mfma_f32_16x16x32_bf16 v[20:23], v[64:67], v[152:155], v[20:23]
    v_mfma_f32_16x16x32_bf16 v[120:123], v[64:67], v[64:67], v[120:123]
    v_mfma_f32_16x16x32_bf16 v[20:23], v[68:71], v[152:155], v[20:23]
    v_mfma_f32_16x16x32_bf16 v[120:123], v[68:71], v[68:71], v[120:123]
    v_add_u32 v26, s51, v6
    v_add_u32 v18, s51, v7
    s_add_u32 s51, s51, 8192
    s_cmp_eq_u32 s51, 57344
    s_cselect_b32 s51, 0, s51
    s_waitcnt vmcnt(8)
    ds_read_b128 v[64:67], v26
    ds_read_b128 v[68:71], v18
    s_waitcnt lgkmcnt(2)
    v_mfma_f32_16x16x32_bf16 v[20:23], v[56:59], v[152:155], v[20:23]
    v_mfma_f32_16x16x32_bf16 v[120:123], v[56:59], v[56:59], v[120:123]
    v_mfma_f32_16x16x32_bf16 v[20:23], v[60:63], v[152:155], v[20:23]
    v_mfma_f32_16x16x32_bf16 v[120:123], v[60:63], v[60:63], v[120:123]
    v_add_u32 v26, s51, v6
    v_add_u32 v18, s51, v7
    s_add_u32 s51, s51, 8192
    s_cmp_eq_u32 s51, 57344
    s_cselect_b32 s51, 0, s51
    s_waitcnt vmcnt(6)
    ds_read_b128 v[56:59], v26
    ds_read_b128 v[60:63], v18
    s_waitcnt lgkmcnt(2)
    v_mfma_f32_16x16x32_bf16 v[20:23], v[64:67], v[152:155], v[20:23]
    v_mfma_f32_16x16x32_bf16 v[120:123], v[64:67], v[64:67], v[120:123]
    v_mfma_f32_16x16x32_bf16 v[20:23], v[68:71], v[152:155], v[20:23]
    v_mfma_f32_16x16x32_bf16 v[120:123], v[68:71], v[68:71], v[120:123]
    v_add_u32 v26, s51, v6
    v_add_u32 v18, s51, v7
    s_add_u32 s51, s51, 8192
    s_cmp_eq_u32 s51, 57344
    s_cselect_b32 s51, 0, s51
    s_waitcnt vmcnt(4)
    ds_read_b128 v[64:67], v26
    ds_read_b128 v[68:71], v18
    s_waitcnt lgkmcnt(2)
    v_mfma_f32_16x16x32_bf16 v[20:23], v[56:59], v[152:155], v[20:23]
    v_mfma_f32_16x16x32_bf16 v[120:123], v[56:59], v[56:59], v[120:123]
    v_mfma_f32_16x16x32_bf16 v[20:23], v[60:63], v[152:155], v[20:23]
    v_mfma_f32_16x16x32_bf16 v[120:123], v[60:63], v[60:63], v[120:123]
    v_add_u32 v26, s51, v6
    v_add_u32 v18, s51, v7
    s_waitcnt vmcnt(2)
    ds_read_b128 v[56:59], v26
    ds_read_b128 v[60:63], v18
    s_waitcnt lgkmcnt(2)
    v_mfma_f32_16x16x32_bf16 v[20:23], v[64:67], v[152:155], v[20:23]
    v_mfma_f32_16x16x32_bf16 v[120:123], v[64:67], v[64:67], v[120:123]
    v_mfma_f32_16x16x32_bf16 v[20:23], v[68:71], v[152:155], v[20:23]
    v_mfma_f32_16x16x32_bf16 v[120:123], v[68:71], v[68:71], v[120:123]
    s_waitcnt lgkmcnt(0)
    v_mfma_f32_16x16x32_bf16 v[20:23], v[56:59], v[152:155], v[20:23]
    v_mfma_f32_16x16x32_bf16 v[120:123], v[56:59], v[56:59], v[120:123]
    v_mfma_f32_16x16x32_bf16 v[20:23], v[60:63], v[152:155], v[20:23]
    v_mfma_f32_16x16x32_bf16 v[120:123], v[60:63], v[60:63], v[120:123]
    s_barrier
    ds_read_b128 v[56:59], v4 offset:0
    ds_read_b128 v[60:63], v4 offset:2048
    ds_read_b128 v[64:67], v4 offset:4096
    ds_read_b128 v[68:71], v4 offset:6144
    ds_read_b128 v[72:75], v5 offset:0
    ds_read_b128 v[76:79], v5 offset:2048
    ds_read_b128 v[80:83], v5 offset:4096
    s_waitcnt lgkmcnt(6)
    v_mfma_f32_16x16x32_bf16 v[88:91], v[56:59], v[28:31], 0
    ds_read_b128 v[84:87], v5 offset:6144
    s_waitcnt lgkmcnt(6)
    v_mfma_f32_16x16x32_bf16 v[92:95], v[60:63], v[28:31], 0
    ds_read_b128 v[56:59], v4 offset:8192
    s_waitcnt lgkmcnt(6)
    v_mfma_f32_16x16x32_bf16 v[96:99], v[64:67], v[28:31], 0
    ds_read_b128 v[60:63], v4 offset:10240
    s_waitcnt lgkmcnt(6)
    v_mfma_f32_16x16x32_bf16 v[100:103], v[68:71], v[28:31], 0
    ds_read_b128 v[64:67], v4 offset:12288
    s_add_u32 m0, s35, 57344
    s_nop 0
    buffer_load_dwordx4 v250, s[40:43], s32 offen lds
    s_waitcnt lgkmcnt(6)
    v_mfma_f32_16x16x32_bf16 v[88:91], v[72:75], v[32:35], v[88:91]
    ds_read_b128 v[68:71], v4 offset:14336
    v_and_b32 v26, 3, v1
    s_waitcnt lgkmcnt(6)
    v_mfma_f32_16x16x32_bf16 v[92:95], v[76:79], v[32:35], v[92:95]
    ds_read_b128 v[72:75], v5 offset:8192
    v_cmp_eq_u32 s[52:53], 1, v26
    s_waitcnt lgkmcnt(6)
    v_mfma_f32_16x16x32_bf16 v[96:99], v[80:83], v[32:35], v[96:99]
    ds_read_b128 v[76:79], v5 offset:10240
    v_cmp_eq_u32 s[54:55], 2, v26
    s_waitcnt lgkmcnt(6)
    v_mfma_f32_16x16x32_bf16 v[100:103], v[84:87], v[32:35], v[100:103]
    ds_read_b128 v[80:83], v5 offset:12288
    v_cmp_eq_u32 s[56:57], 3, v26
    s_waitcnt lgkmcnt(6)
    v_mfma_f32_16x16x32_bf16 v[88:91], v[56:59], v[36:39], v[88:91]
    ds_read_b128 v[84:87], v5 offset:14336
    v_bfe_u32 v26, v1, 2, 2
    s_waitcnt lgkmcnt(6)
    v_mfma_f32_16x16x32_bf16 v[92:95], v[60:63], v[36:39], v[92:95]
    ds_read_b128 v[56:59], v4 offset:16384
    v_lshrrev_b32 v19, 4, v1
    s_waitcnt lgkmcnt(6)
    v_mfma_f32_16x16x32_bf16 v[96:99], v[64:67], v[36:39], v[96:99]
    ds_read_b128 v[60:63], v4 offset:18432
    v_cmp_eq_u32 s[58:59], v26, v19
    s_waitcnt lgkmcnt(6)
    v_mfma_f32_16x16x32_bf16 v[100:103], v[68:71], v[36:39], v[100:103]
    ds_read_b128 v[64:67], v4 offset:20480
    v_cndmask_b32 v24, v20, v21, s[52:53]
    s_add_u32 m0, s35, 61440
    s_nop 0
    buffer_load_dwordx4 v250, s[44:47], s32 offen lds
    s_waitcnt lgkmcnt(6)
    v_mfma_f32_16x16x32_bf16 v[88:91], v[72:75], v[40:43], v[88:91]
    ds_read_b128 v[68:71], v4 offset:22528
    v_cndmask_b32 v25, v120, v121, s[52:53]
    s_waitcnt lgkmcnt(6)
    v_mfma_f32_16x16x32_bf16 v[92:95], v[76:79], v[40:43], v[92:95]
    ds_read_b128 v[72:75], v5 offset:16384
    v_cndmask_b32 v24, v24, v22, s[54:55]
    s_waitcnt lgkmcnt(6)
    v_mfma_f32_16x16x32_bf16 v[96:99], v[80:83], v[40:43], v[96:99]
    ds_read_b128 v[76:79], v5 offset:18432
    v_cndmask_b32 v25, v25, v122, s[54:55]
    s_waitcnt lgkmcnt(6)
    v_mfma_f32_16x16x32_bf16 v[100:103], v[84:87], v[40:43], v[100:103]
    ds_read_b128 v[80:83], v5 offset:20480
    v_cndmask_b32 v24, v24, v23, s[56:57]
    s_waitcnt lgkmcnt(6)
    v_mfma_f32_16x16x32_bf16 v[88:91], v[56:59], v[44:47], v[88:91]
    ds_read_b128 v[84:87], v5 offset:22528
    v_cndmask_b32 v25, v25, v123, s[56:57]
    s_waitcnt lgkmcnt(6)
    v_mfma_f32_16x16x32_bf16 v[92:95], v[60:63], v[44:47], v[92:95]
    ds_read_b128 v[56:59], v4 offset:24576
    v_mul_f32 v24, 0x3b124925, v24
    s_waitcnt lgkmcnt(6)
    v_mfma_f32_16x16x32_bf16 v[96:99], v[64:67], v[44:47], v[96:99]
    ds_read_b128 v[60:63], v4 offset:26624
    v_mul_f32 v25, 0x3b124925, v25
    s_waitcnt lgkmcnt(6)
    v_mfma_f32_16x16x32_bf16 v[100:103], v[68:71], v[44:47], v[100:103]
    ds_read_b128 v[64:67], v4 offset:28672
    v_and_b32 v26, 15, v1
    s_add_u32 m0, s35, 65536
    s_add_u32 s32, s32, 57344
    buffer_load_dwordx4 v250, s[40:43], s32 offen lds
    s_waitcnt lgkmcnt(6)
    v_mfma_f32_16x16x32_bf16 v[88:91], v[72:75], v[48:51], v[88:91]
    ds_read_b128 v[68:71], v4 offset:30720
    v_fma_f32 v25, -v24, v24, v25
    s_waitcnt lgkmcnt(6)
    v_mfma_f32_16x16x32_bf16 v[92:95], v[76:79], v[48:51], v[92:95]
    ds_read_b128 v[72:75], v5 offset:24576
    s_lshl_b32 s33, s20, 6
    s_add_u32 s33, s33, 122880
    s_waitcnt lgkmcnt(6)
    v_mfma_f32_16x16x32_bf16 v[96:99], v[80:83], v[48:51], v[96:99]
    ds_read_b128 v[76:79], v5 offset:26624
    v_max_f32 v25, 0, v25
    s_waitcnt lgkmcnt(6)
    v_mfma_f32_16x16x32_bf16 v[100:103], v[84:87], v[48:51], v[100:103]
    ds_read_b128 v[80:83], v5 offset:28672
    v_lshl_add_u32 v19, v26, 2, s33
    s_waitcnt lgkmcnt(6)
    v_mfma_f32_16x16x32_bf16 v[88:91], v[56:59], v[52:55], v[88:91]
    ds_read_b128 v[84:87], v5 offset:30720
    v_add_f32 v25, 0x3727c5ac, v25
    s_waitcnt lgkmcnt(6)
    v_mfma_f32_16x16x32_bf16 v[92:95], v[60:63], v[52:55], v[92:95]
    ds_read_b128 v[56:59], v4 offset:32768
    v_fmac_f32 v156, v156, v17
    s_waitcnt lgkmcnt(6)
    v_mfma_f32_16x16x32_bf16 v[96:99], v[64:67], v[52:55], v[96:99]
    ds_read_b128 v[60:63], v4 offset:34816
    v_rsq_f32 v25, v25
    s_waitcnt lgkmcnt(6)
    v_mfma_f32_16x16x32_bf16 v[100:103], v[68:71], v[52:55], v[100:103]
    ds_read_b128 v[64:67], v4 offset:36864
    v_lshrrev_b32 v21, 2, v26
    s_add_u32 m0, s35, 69632
    s_nop 0
    buffer_load_dwordx4 v250, s[44:47], s32 offen lds
    s_waitcnt lgkmcnt(6)
    v_mfma_f32_16x16x32_bf16 v[104:107], v[72:75], v[28:31], 0
    ds_read_b128 v[68:71], v4 offset:38912
    v_and_b32 v26, 3, v26
    s_waitcnt lgkmcnt(6)
    v_mfma_f32_16x16x32_bf16 v[108:111], v[76:79], v[28:31], 0
    ds_read_b128 v[72:75], v5 offset:32768
    v_mul_f32 v20, v24, v25
    s_waitcnt lgkmcnt(6)
    v_mfma_f32_16x16x32_bf16 v[112:115], v[80:83], v[28:31], 0
    ds_read_b128 v[76:79], v5 offset:34816
    v_lshl_add_u32 v26, v21, 4, v26
    s_waitcnt lgkmcnt(6)
    v_mfma_f32_16x16x32_bf16 v[116:119], v[84:87], v[28:31], 0
    ds_read_b128 v[80:83], v5 offset:36864
    v_lshlrev_b32 v26, 7, v26
    s_waitcnt lgkmcnt(6)
    v_mfma_f32_16x16x32_bf16 v[104:107], v[56:59], v[32:35], v[104:107]
    ds_read_b128 v[84:87], v5 offset:38912
    s_lshl_b32 s33, s20, 7
    s_waitcnt lgkmcnt(6)
    v_mfma_f32_16x16x32_bf16 v[108:111], v[60:63], v[32:35], v[108:111]
    ds_read_b128 v[56:59], v4 offset:40960
    s_add_u32 s33, s33, s24
    s_waitcnt lgkmcnt(6)
    v_mfma_f32_16x16x32_bf16 v[112:115], v[64:67], v[32:35], v[112:115]
    ds_read_b128 v[60:63], v4 offset:43008
    s_lshl2_add_u32 s33, s33, 11534336
    s_waitcnt lgkmcnt(6)
    v_mfma_f32_16x16x32_bf16 v[116:119], v[68:71], v[32:35], v[116:119]
    ds_read_b128 v[64:67], v4 offset:45056
    s_cmp_eq_u32 s22, 0
    s_cselect_b32 s33, s33, 0x40000000
    s_add_u32 m0, s35, 73728
    s_add_u32 s32, s32, 57344
    buffer_load_dwordx4 v250, s[40:43], s32 offen lds
    s_waitcnt lgkmcnt(6)
    v_mfma_f32_16x16x32_bf16 v[104:107], v[72:75], v[36:39], v[104:107]
    ds_read_b128 v[68:71], v4 offset:47104
    s_waitcnt lgkmcnt(6)
    v_mfma_f32_16x16x32_bf16 v[108:111], v[76:79], v[36:39], v[108:111]
    ds_read_b128 v[72:75], v5 offset:40960
    s_waitcnt lgkmcnt(6)
    v_mfma_f32_16x16x32_bf16 v[112:115], v[80:83], v[36:39], v[112:115]
    ds_read_b128 v[76:79], v5 offset:43008
    s_waitcnt lgkmcnt(6)
    v_mfma_f32_16x16x32_bf16 v[116:119], v[84:87], v[36:39], v[116:119]
    ds_read_b128 v[80:83], v5 offset:45056
    s_waitcnt lgkmcnt(6)
    v_mfma_f32_16x16x32_bf16 v[104:107], v[56:59], v[40:43], v[104:107]
    ds_read_b128 v[84:87], v5 offset:47104
    s_mov_b64 exec, s[58:59]
    ds_write_b32 v19, v25
    ds_write_b32 v19, v20 offset:256
    buffer_store_dword v24, v26, s[8:11], s33 offen sc1
    s_mov_b64 exec, -1
    s_waitcnt lgkmcnt(8)
    v_mfma_f32_16x16x32_bf16 v[108:111], v[60:63], v[40:43], v[108:111]
    ds_read_b128 v[56:59], v4 offset:49152
    s_waitcnt vmcnt(6)
    s_mov_b32 s50, 0x05040100
    s_mov_b32 s51, 0x07060302
    s_waitcnt lgkmcnt(8)
    v_mfma_f32_16x16x32_bf16 v[112:115], v[64:67], v[40:43], v[112:115]
    ds_read_b128 v[60:63], v4 offset:51200
    v_perm_b32 v168, v164, v160, s50
    v_perm_b32 v169, v164, v160, s51
    s_waitcnt lgkmcnt(8)
    v_mfma_f32_16x16x32_bf16 v[116:119], v[68:71], v[40:43], v[116:119]
    ds_read_b128 v[64:67], v4 offset:53248
    v_perm_b32 v170, v165, v161, s50
    v_perm_b32 v171, v165, v161, s51
    s_add_u32 m0, s35, 77824
    s_nop 0
    buffer_load_dwordx4 v250, s[44:47], s32 offen lds
    s_waitcnt lgkmcnt(8)
    v_mfma_f32_16x16x32_bf16 v[104:107], v[72:75], v[44:47], v[104:107]
    ds_read_b128 v[68:71], v4 offset:55296
    v_perm_b32 v172, v166, v162, s50
    v_perm_b32 v173, v166, v162, s51
    s_waitcnt lgkmcnt(8)
    v_mfma_f32_16x16x32_bf16 v[108:111], v[76:79], v[44:47], v[108:111]
    ds_read_b128 v[72:75], v5 offset:49152
    v_perm_b32 v174, v167, v163, s50
    v_perm_b32 v175, v167, v163, s51
    s_waitcnt lgkmcnt(8)
    v_mfma_f32_16x16x32_bf16 v[112:115], v[80:83], v[44:47], v[112:115]
    ds_read_b128 v[76:79], v5 offset:51200
    ds_write2st64_b32 v230, v168, v169 offset0:0 offset1:1
    s_waitcnt lgkmcnt(9)
    v_mfma_f32_16x16x32_bf16 v[116:119], v[84:87], v[44:47], v[116:119]
    ds_read_b128 v[80:83], v5 offset:53248
    ds_write2st64_b32 v230, v170, v171 offset0:2 offset1:3
    s_waitcnt lgkmcnt(8)
    v_mfma_f32_16x16x32_bf16 v[104:107], v[56:59], v[48:51], v[104:107]
    ds_read_b128 v[84:87], v5 offset:55296
    ds_write2st64_b32 v230, v172, v173 offset0:4 offset1:5
    s_waitcnt lgkmcnt(9)
    v_mfma_f32_16x16x32_bf16 v[108:111], v[60:63], v[48:51], v[108:111]
    ds_write2st64_b32 v230, v174, v175 offset0:6 offset1:7
    s_waitcnt lgkmcnt(9)
    v_mfma_f32_16x16x32_bf16 v[112:115], v[64:67], v[48:51], v[112:115]
    s_add_u32 s50, s27, 114688
    v_lshl_add_u32 v231, v1, 4, s50
    s_waitcnt lgkmcnt(8)
    v_mfma_f32_16x16x32_bf16 v[116:119], v[68:71], v[48:51], v[116:119]
    v_lshrrev_b32 v230, 4, v1
    v_and_b32 v232, 15, v1
    s_lshl2_add_u32 s50, s22, s20
    s_waitcnt lgkmcnt(7)
    v_mfma_f32_16x16x32_bf16 v[104:107], v[72:75], v[52:55], v[104:107]
    v_lshlrev_b32 v232, 4, v232
    s_lshl_b32 s50, s50, 16
    s_and_b32 s51, s24, 3
    s_waitcnt lgkmcnt(6)
    v_mfma_f32_16x16x32_bf16 v[108:111], v[76:79], v[52:55], v[108:111]
    v_lshl_add_u32 v230, v230, 13, v232
    s_lshl_b32 s51, s51, 11
    s_add_u32 s50, s50, s51
    s_waitcnt lgkmcnt(4)
    v_mfma_f32_16x16x32_bf16 v[112:115], v[80:83], v[52:55], v[112:115]
    s_lshr_b32 s51, s24, 2
    s_lshl_b32 s51, s51, 8
    s_add_u32 s50, s50, s51
    s_waitcnt lgkmcnt(2)
    v_mfma_f32_16x16x32_bf16 v[116:119], v[84:87], v[52:55], v[116:119]
    s_add_u32 s50, s50, 2097152
    s_add_u32 s51, s50, 32768
    s_waitcnt lgkmcnt(0)
    s_barrier
    ds_read_b128 v[160:163], v231
    ds_read_b128 v[164:167], v231 offset:1024
    v_lshrrev_b32 v24, 4, v1
    v_lshlrev_b32 v24, 4, v24
    v_add_u32 v25, 122880, v24
    ds_read_b128 v[124:127], v25 offset:0
    ds_read_b128 v[140:143], v25 offset:256
    ds_read_b128 v[128:131], v25 offset:64
    ds_read_b128 v[144:147], v25 offset:320
    ds_read_b128 v[132:135], v25 offset:128
    ds_read_b128 v[148:151], v25 offset:384
    ds_read_b128 v[136:139], v25 offset:192
    ds_read_b128 v[152:155], v25 offset:448
    v_pk_fma_f32 v[88:89], v[104:105], v[16:17], v[88:89] op_sel:[0,1,0]
    v_pk_fma_f32 v[90:91], v[106:107], v[16:17], v[90:91] op_sel:[0,1,0]
    v_pk_fma_f32 v[92:93], v[108:109], v[16:17], v[92:93] op_sel:[0,1,0]
    v_pk_fma_f32 v[94:95], v[110:111], v[16:17], v[94:95] op_sel:[0,1,0]
    v_pk_fma_f32 v[96:97], v[112:113], v[16:17], v[96:97] op_sel:[0,1,0]
    v_pk_fma_f32 v[98:99], v[114:115], v[16:17], v[98:99] op_sel:[0,1,0]
    v_pk_fma_f32 v[100:101], v[116:117], v[16:17], v[100:101] op_sel:[0,1,0]
    v_pk_fma_f32 v[102:103], v[118:119], v[16:17], v[102:103] op_sel:[0,1,0]
    s_waitcnt lgkmcnt(8)
    buffer_store_dwordx4 v[160:163], v230, s[8:11], s50 offen sc1
    buffer_store_dwordx4 v[164:167], v230, s[8:11], s51 offen sc1
    v_and_b32 v8, 15, v1
    v_and_b32 v9, 7, v1
    v_lshrrev_b32 v10, 3, v24
    v_xor_b32 v10, v10, v9
    v_lshlrev_b32 v10, 4, v10
    v_lshl_add_u32 v10, v8, 7, v10
    v_add_u32 v10, s27, v10
    v_xor_b32 v11, 16, v10
    v_lshlrev_b32 v3, 4, v1
    v_add_u32 v12, s27, v3
    v_lshrrev_b32 v13, 3, v1
    v_xor_b32 v9, v9, v13
    v_lshlrev_b32 v9, 4, v9
    v_lshl_add_u32 v13, v13, 13, v9
    s_lshl_b32 s28, s28, 13
    s_lshl_b32 s30, s30, 12
    s_lshl_b32 s33, s24, 7
    s_add_u32 s33, s33, s30
    s_add_u32 s33, s33, s28
    s_add_u32 s34, s33, 0x10000
    s_waitcnt lgkmcnt(4)
    v_pk_mul_f32 v[88:89], v[88:89], v[124:125]
    v_pk_mul_f32 v[90:91], v[90:91], v[126:127]
    v_pk_mul_f32 v[92:93], v[92:93], v[128:129]
    v_pk_mul_f32 v[94:95], v[94:95], v[130:131]
    v_pk_fma_f32 v[88:89], v[140:141], v[156:157], v[88:89] op_sel_hi:[1,0,1] neg_lo:[1,0,0] neg_hi:[1,0,0]
    v_pk_fma_f32 v[90:91], v[142:143], v[156:157], v[90:91] op_sel_hi:[1,0,1] neg_lo:[1,0,0] neg_hi:[1,0,0]
    v_pk_fma_f32 v[92:93], v[144:145], v[156:157], v[92:93] op_sel_hi:[1,0,1] neg_lo:[1,0,0] neg_hi:[1,0,0]
    v_pk_fma_f32 v[94:95], v[146:147], v[156:157], v[94:95] op_sel_hi:[1,0,1] neg_lo:[1,0,0] neg_hi:[1,0,0]
    v_cvt_pk_bf16_f32 v56, v88, v89
    v_cvt_pk_bf16_f32 v57, v90, v91
    v_cvt_pk_bf16_f32 v58, v92, v93
    v_cvt_pk_bf16_f32 v59, v94, v95
    s_waitcnt lgkmcnt(0)
    v_pk_mul_f32 v[96:97], v[96:97], v[132:133]
    v_pk_mul_f32 v[98:99], v[98:99], v[134:135]
    v_pk_mul_f32 v[100:101], v[100:101], v[136:137]
    v_pk_mul_f32 v[102:103], v[102:103], v[138:139]
    v_pk_fma_f32 v[96:97], v[148:149], v[156:157], v[96:97] op_sel_hi:[1,0,1] neg_lo:[1,0,0] neg_hi:[1,0,0]
    v_pk_fma_f32 v[98:99], v[150:151], v[156:157], v[98:99] op_sel_hi:[1,0,1] neg_lo:[1,0,0] neg_hi:[1,0,0]
    v_pk_fma_f32 v[100:101], v[152:153], v[156:157], v[100:101] op_sel_hi:[1,0,1] neg_lo:[1,0,0] neg_hi:[1,0,0]
    v_pk_fma_f32 v[102:103], v[154:155], v[156:157], v[102:103] op_sel_hi:[1,0,1] neg_lo:[1,0,0] neg_hi:[1,0,0]
    v_cvt_pk_bf16_f32 v60, v96, v97
    v_cvt_pk_bf16_f32 v61, v98, v99
    v_cvt_pk_bf16_f32 v62, v100, v101
    v_cvt_pk_bf16_f32 v63, v102, v103
    ds_write_b128 v10, v[56:59]
    ds_write_b128 v11, v[60:63]
    s_waitcnt lgkmcnt(0)
    ds_read_b128 v[64:67], v12
    ds_read_b128 v[68:71], v12 offset:1024
    v_lshlrev_b32 v30, 2, v1
    v_min_u32 v14, 28, v30
    s_waitcnt lgkmcnt(1)
    buffer_store_dwordx4 v[64:67], v13, s[8:11], s33 offen sc1
    s_waitcnt lgkmcnt(0)
    buffer_store_dwordx4 v[68:71], v13, s[8:11], s34 offen sc1
    global_load_dword v31, v14, s[62:63] sc1
    v_lshrrev_b32 v4, 4, v1
    v_and_b32 v5, 15, v1
    v_mov_b32 v2, 1
    v_min_u32 v0, 220, v30
    v_and_b32 v7, 7, v1
    v_xor_b32 v7, v7, v4
    v_lshrrev_b32 v8, 3, v1
    v_lshlrev_b32 v8, 7, v8
    v_lshl_add_u32 v211, v7, 4, v8
    v_xor_b32 v212, 64, v211
    s_lshl_b32 s33, s21, 10
    s_add_u32 s33, s33, 11599872
    s_lshl2_add_u32 s39, s25, s33
    s_getreg_b32 s60, hwreg(HW_REG_XCC_ID, 0, 4)
    s_lshr_b32 s26, s2, 5
    s_lshl_b32 s26, s26, 9
    s_add_u32 s51, s26, 11640832
    v_lshlrev_b32 v214, 3, v1
    v_and_b32 v213, 124, v30
    s_lshl_b32 s26, s22, 5
    s_add_u32 s26, s26, s24
    s_lshl2_add_u32 s26, s26, s20
    s_lshl2_add_u32 s52, s26, 11640832
    s_lshl1_add_u32 s24, s21, s23
    s_lshl_b32 s53, s20, 4
    v_add_u32 v210, s53, v5
    v_cvt_f32_u32 v208, v210
    v_cvt_f32_u32 v209, v4
    v_mul_f32 v160, 0x3c800000, v208
    v_mul_f32 v161, 0x41000000, v209
    v_mul_f32 v161, v161, v160
    v_mov_b32 v184, v161
    v_fmamk_f32 v185, v160, 0x3f800000, v161
    v_fmamk_f32 v186, v160, 0x40000000, v161
    v_fmamk_f32 v187, v160, 0x40400000, v161
    v_fmamk_f32 v188, v160, 0x40800000, v161
    v_fmamk_f32 v189, v160, 0x40a00000, v161
    v_fmamk_f32 v190, v160, 0x40c00000, v161
    v_fmamk_f32 v191, v160, 0x40e00000, v161
    v_cos_f32 v192, v184
    v_cos_f32 v193, v185
    v_cos_f32 v194, v186
    v_cos_f32 v195, v187
    v_cos_f32 v196, v188
    v_cos_f32 v197, v189
    v_cos_f32 v198, v190
    v_cos_f32 v199, v191
    v_sin_f32 v184, v184
    v_sin_f32 v185, v185
    v_sin_f32 v186, v186
    v_sin_f32 v187, v187
    v_sin_f32 v188, v188
    v_sin_f32 v189, v189
    v_sin_f32 v190, v190
    v_sin_f32 v191, v191
    v_cvt_pk_bf16_f32 v32, v192, v193
    v_cvt_pk_bf16_f32 v33, v194, v195
    v_cvt_pk_bf16_f32 v34, v196, v197
    v_cvt_pk_bf16_f32 v35, v198, v199
    v_cvt_pk_bf16_f32 v40, v184, v185
    v_cvt_pk_bf16_f32 v41, v186, v187
    v_cvt_pk_bf16_f32 v42, v188, v189
    v_cvt_pk_bf16_f32 v43, v190, v191
    s_mov_b32 s54, 0x80008000
    v_and_b32 v210, 1, v1
    v_mul_u32_u24 v210, 0x8000, v210
    v_lshl_or_b32 v210, v210, 16, v210
    v_xor_b32 v36, v210, v32
    v_xor_b32 v44, v210, v40
    v_xor_b32 v37, v210, v33
    v_xor_b32 v45, v210, v41
    v_xor_b32 v38, v210, v34
    v_xor_b32 v46, v210, v42
    v_xor_b32 v39, v210, v35
    v_xor_b32 v47, v210, v43
    v_xor_b32 v48, s54, v40
    v_xor_b32 v49, s54, v41
    v_xor_b32 v50, s54, v42
    v_xor_b32 v51, s54, v43
    v_xor_b32 v52, s54, v44
    v_xor_b32 v53, s54, v45
    v_xor_b32 v54, s54, v46
    v_xor_b32 v55, s54, v47
    s_waitcnt vmcnt(0)
    v_cmp_eq_u32 vcc, 0, v31
    s_mov_b32 s50, 262144
    s_cbranch_vccnz L_se_poll_5
L_se_done_6:
    buffer_store_dword v2, off, s[8:11], s52 sc1
    s_barrier
    s_add_u32 m0, s35, 81920
    s_add_u32 s32, s32, 57344
    buffer_load_dwordx4 v250, s[40:43], s32 offen lds
    s_add_u32 m0, s35, 86016
    s_nop 0
    buffer_load_dwordx4 v250, s[44:47], s32 offen lds
    s_add_u32 m0, s35, 90112
    s_add_u32 s32, s32, 57344
    buffer_load_dwordx4 v250, s[40:43], s32 offen lds
    s_add_u32 m0, s35, 94208
    s_nop 0
    buffer_load_dwordx4 v250, s[44:47], s32 offen lds
    s_add_u32 m0, s35, 98304
    s_add_u32 s32, s32, 57344
    buffer_load_dwordx4 v250, s[40:43], s32 offen lds
    s_add_u32 m0, s35, 102400
    s_nop 0
    buffer_load_dwordx4 v250, s[44:47], s32 offen lds
    s_add_u32 m0, s35, 106496
    s_add_u32 s32, s32, 57344
    buffer_load_dwordx4 v250, s[40:43], s32 offen lds
    s_add_u32 m0, s35, 110592
    s_nop 0
    buffer_load_dwordx4 v250, s[44:47], s32 offen lds
    s_add_u32 m0, s35, 123904
    s_add_u32 s32, s32, 57344
    buffer_load_dwordx4 v250, s[40:43], s32 offen lds
    s_add_u32 m0, s35, 128000
    s_nop 0
    buffer_load_dwordx4 v250, s[44:47], s32 offen lds
    ds_read_b64_tr_b16 a[0:1], v251 offset:0
    ds_read_b64_tr_b16 a[2:3], v251 offset:1024
    ds_read_b64_tr_b16 a[4:5], v251 offset:4096
    ds_read_b64_tr_b16 a[6:7], v251 offset:5120
    ds_read_b64_tr_b16 a[8:9], v251 offset:8192
    ds_read_b64_tr_b16 a[10:11], v251 offset:9216
    ds_read_b64_tr_b16 a[12:13], v251 offset:12288
    ds_read_b64_tr_b16 a[14:15], v251 offset:13312
    ds_read_b64_tr_b16 a[16:17], v251 offset:16384
    ds_read_b64_tr_b16 a[18:19], v251 offset:17408
    ds_read_b64_tr_b16 a[20:21], v251 offset:20480
    ds_read_b64_tr_b16 a[22:23], v251 offset:21504
    v_lshrrev_b32 v210, 1, v5
    v_xor_b32 v210, v210, v4
    v_lshlrev_b32 v210, 4, v210
    v_lshl_add_u32 v176, v5, 7, v210
    v_xor_b32 v177, 64, v176
    v_cvt_f32_u32 v210, v5
    v_mul_f32 v160, 0x3d000000, v210
    v_mul_f32 v161, 4.0, v209
    v_mul_f32 v161, v161, v160
    v_mov_b32 v184, v161
    v_fmamk_f32 v185, v160, 0x3f800000, v161
    v_fmamk_f32 v186, v160, 0x40000000, v161
    v_fmamk_f32 v187, v160, 0x40400000, v161
    v_fmamk_f32 v188, v160, 0x41800000, v161
    v_fmamk_f32 v189, v160, 0x41880000, v161
    v_fmamk_f32 v190, v160, 0x41900000, v161
    v_fmamk_f32 v191, v160, 0x41980000, v161
    v_cos_f32 v192, v184
    v_cos_f32 v193, v185
    v_cos_f32 v194, v186
    v_cos_f32 v195, v187
    v_cos_f32 v196, v188
    v_cos_f32 v197, v189
    v_cos_f32 v198, v190
    v_cos_f32 v199, v191
    v_sin_f32 v184, v184
    v_sin_f32 v185, v185
    v_sin_f32 v186, v186
    v_sin_f32 v187, v187
    v_sin_f32 v188, v188
    v_sin_f32 v189, v189
    v_sin_f32 v190, v190
    v_sin_f32 v191, v191
    v_cvt_pk_bf16_f32 v56, v192, v193
    v_cvt_pk_bf16_f32 v57, v194, v195
    v_cvt_pk_bf16_f32 v58, v196, v197
    v_cvt_pk_bf16_f32 v59, v198, v199
    v_cvt_pk_bf16_f32 v64, v184, v185
    v_cvt_pk_bf16_f32 v65, v186, v187
    v_cvt_pk_bf16_f32 v66, v188, v189
    v_cvt_pk_bf16_f32 v67, v190, v191
    s_brev_b32 s55, 1
    v_xor_b32 v60, s55, v56
    v_xor_b32 v68, s55, v64
    v_xor_b32 v61, s55, v57
    v_xor_b32 v69, s55, v65
    v_xor_b32 v62, s55, v58
    v_xor_b32 v70, s55, v66
    v_xor_b32 v63, s55, v59
    v_xor_b32 v71, s55, v67
    v_xor_b32 v72, s54, v64
    v_xor_b32 v73, s54, v65
    v_xor_b32 v74, s54, v66
    v_xor_b32 v75, s54, v67
    v_xor_b32 v76, s54, v68
    v_xor_b32 v77, s54, v69
    v_xor_b32 v78, s54, v70
    v_xor_b32 v79, s54, v71
    v_mul_f32 v160, 0x3a000000, v208
    v_mul_f32 v161, 4.0, v209
    v_mul_f32 v161, v161, v160
    v_mov_b32 v88, v161
    v_fmamk_f32 v89, v160, 0x3f800000, v161
    v_fmamk_f32 v90, v160, 0x40000000, v161
    v_fmamk_f32 v91, v160, 0x40400000, v161
    v_fmamk_f32 v92, v160, 0x41800000, v161
    v_fmamk_f32 v93, v160, 0x41880000, v161
    v_fmamk_f32 v94, v160, 0x41900000, v161
    v_fmamk_f32 v95, v160, 0x41980000, v161
    v_cos_f32 v80, v88
    v_cos_f32 v81, v89
    v_cos_f32 v82, v90
    v_cos_f32 v83, v91
    v_cos_f32 v84, v92
    v_cos_f32 v85, v93
    v_cos_f32 v86, v94
    v_cos_f32 v87, v95
    v_sin_f32 v88, v88
    v_sin_f32 v89, v89
    v_sin_f32 v90, v90
    v_sin_f32 v91, v91
    v_sin_f32 v92, v92
    v_sin_f32 v93, v93
    v_sin_f32 v94, v94
    v_sin_f32 v95, v95
    v_mul_f32 v184, 0x3a000000, v210
    v_add_f32 v185, 0x3c000000, v184
    v_lshl_add_u32 v208, v4, 2, s53
    v_cvt_f32_u32 v208, v208
    v_mul_f32 v104, v208, v184
    v_mul_f32 v108, v208, v185
    v_add_f32 v208, 1.0, v208
    v_mul_f32 v105, v208, v184
    v_mul_f32 v109, v208, v185
    v_add_f32 v208, 1.0, v208
    v_mul_f32 v106, v208, v184
    v_mul_f32 v110, v208, v185
    v_add_f32 v208, 1.0, v208
    v_mul_f32 v107, v208, v184
    v_mul_f32 v111, v208, v185
    v_cos_f32 v96, v104
    v_cos_f32 v97, v105
    v_cos_f32 v98, v106
    v_cos_f32 v99, v107
    v_cos_f32 v100, v108
    v_cos_f32 v101, v109
    v_cos_f32 v102, v110
    v_cos_f32 v103, v111
    v_sin_f32 v104, v104
    v_sin_f32 v105, v105
    v_sin_f32 v106, v106
    v_sin_f32 v107, v107
    v_sin_f32 v108, v108
    v_sin_f32 v109, v109
    v_sin_f32 v110, v110
    v_sin_f32 v111, v111
    s_cmp_eq_u32 s2, 223
    s_mov_b32 s55, 0x36124925
    s_cselect_b32 s55, 0x35924925, s55
    v_mul_f32 v96, s55, v96
    v_mul_f32 v104, s55, v104
    v_mul_f32 v97, s55, v97
    v_mul_f32 v105, s55, v105
    v_mul_f32 v98, s55, v98
    v_mul_f32 v106, s55, v106
    v_mul_f32 v99, s55, v99
    v_mul_f32 v107, s55, v107
    v_mul_f32 v100, s55, v100
    v_mul_f32 v108, s55, v108
    v_mul_f32 v101, s55, v101
    v_mul_f32 v109, s55, v109
    v_mul_f32 v102, s55, v102
    v_mul_f32 v110, s55, v110
    v_mul_f32 v103, s55, v103
    v_mul_f32 v111, s55, v111
    v_lshrrev_b32 v208, 1, v4
    v_lshl_add_u32 v208, v208, 4, v5
    v_lshlrev_b32 v208, 4, v208
    v_and_b32 v209, 1, v4
    v_lshl_add_u32 v208, v209, 3, v208
    s_lshl_b32 s26, s20, 9
    v_add_u32 v208, s26, v208
    s_lshl_b32 s26, s2, 13
    s_add_u32 s56, s26, s27
    s_add_u32 s57, s56, 2097152
    s_add_u32 s58, s26, s35
    s_add_u32 s59, s58, 4096
    s_mov_b32 m0, s27
    s_waitcnt lgkmcnt(0)
    s_barrier
    s_cmp_lg_u32 s20, 0
    s_cbranch_scc1 L_se_ps_9
    s_mov_b32 s50, 262144
    buffer_load_dwordx2 v[216:217], v214, s[8:11], s51 offen sc1
    buffer_load_dwordx2 v[218:219], v214, s[8:11], s51 offen sc1
L_se_pp_7:
    buffer_load_dwordx2 v[220:221], v214, s[8:11], s51 offen sc1
    s_waitcnt vmcnt(2)
    v_and_b32 v216, v216, v217
    v_cmp_eq_u32 vcc, 0, v216
    s_nop 0
    s_cbranch_vccz L_se_pd_8
    buffer_load_dwordx2 v[216:217], v214, s[8:11], s51 offen sc1
    s_waitcnt vmcnt(2)
    v_and_b32 v218, v218, v219
    v_cmp_eq_u32 vcc, 0, v218
    s_nop 0
    s_cbranch_vccz L_se_pd_8
    buffer_load_dwordx2 v[218:219], v214, s[8:11], s51 offen sc1
    s_waitcnt vmcnt(2)
    v_and_b32 v220, v220, v221
    v_cmp_eq_u32 vcc, 0, v220
    s_nop 0
    s_cbranch_vccz L_se_pd_8
    s_sub_u32 s50, s50, 1
    s_cmp_lg_u32 s50, 0
    s_cbranch_scc1 L_se_pp_7
L_se_pd_8:
L_se_ps_9:
    s_waitcnt vmcnt(0)
    s_barrier
    buffer_load_dwordx4 v211, s[8:11], s56 offen sc1 lds
    buffer_load_dwordx4 v212, s[8:11], s56 offen offset:1024 sc1 lds
    buffer_load_dwordx4 v[200:203], v3, s[8:11], s57 offen sc1
    buffer_load_dwordx4 v[204:207], v3, s[8:11], s57 offen offset:1024 sc1
    s_lshl_b32 s26, s60, 2
    s_lshl_b32 s26, 1, s26
    s_lshr_b32 s28, s60, 3
    s_lshl2_add_u32 s28, s28, s33
    s_cmp_lg_u32 s20, 0
    s_cbranch_scc1 L_se_skip_10
    s_mov_b64 exec, 1
    v_mov_b32 v215, s26
    buffer_atomic_add v215, off, s[8:11], s28 offset:768 sc1
    s_mov_b64 exec, -1
L_se_skip_10:
    ds_read_b64_tr_b16 a[24:25], v251 offset:24576
    ds_read_b64_tr_b16 a[26:27], v251 offset:25600
    ds_read_b64_tr_b16 a[28:29], v251 offset:28672
    ds_read_b64_tr_b16 a[30:31], v251 offset:29696
    ds_read_b64_tr_b16 a[32:33], v251 offset:32768
    ds_read_b64_tr_b16 a[34:35], v251 offset:33792
    ds_read_b64_tr_b16 a[36:37], v251 offset:36864
    ds_read_b64_tr_b16 a[38:39], v251 offset:37888
    ds_read_b64_tr_b16 a[40:41], v251 offset:40960
    ds_read_b64_tr_b16 a[42:43], v251 offset:41984
    ds_read_b64_tr_b16 a[44:45], v251 offset:45056
    ds_read_b64_tr_b16 a[46:47], v251 offset:46080
    ds_read_b64_tr_b16 a[48:49], v251 offset:49152
    ds_read_b64_tr_b16 a[50:51], v251 offset:50176
    ds_read_b64_tr_b16 a[52:53], v251 offset:53248
    ds_read_b64_tr_b16 a[54:55], v251 offset:54272
    ds_read_b64_tr_b16 a[56:57], v252 offset:0
    ds_read_b64_tr_b16 a[58:59], v252 offset:1024
    ds_read_b64_tr_b16 a[60:61], v252 offset:4096
    ds_read_b64_tr_b16 a[62:63], v252 offset:5120
    s_add_u32 m0, s35, 132096
    s_add_u32 s32, s32, 57344
    buffer_load_dwordx4 v250, s[40:43], s32 offen lds
    s_add_u32 m0, s35, 136192
    s_nop 0
    buffer_load_dwordx4 v250, s[44:47], s32 offen lds
    s_add_u32 m0, s35, 140288
    s_add_u32 s32, s32, 57344
    buffer_load_dwordx4 v250, s[40:43], s32 offen lds
    s_add_u32 m0, s35, 144384
    s_nop 0
    buffer_load_dwordx4 v250, s[44:47], s32 offen lds
    s_add_u32 m0, s35, 148480
    s_add_u32 s32, s32, 57344
    buffer_load_dwordx4 v250, s[40:43], s32 offen lds
    s_add_u32 m0, s35, 152576
    s_nop 0
    buffer_load_dwordx4 v250, s[44:47], s32 offen lds
    s_waitcnt vmcnt(8)
    s_waitcnt lgkmcnt(0)
    s_barrier
    ds_read_b128 v[112:115], v176 offset:0
    ds_read_b128 v[128:131], v176 offset:4096
    ds_read_b128 v[120:123], v176 offset:2048
    ds_read_b128 v[136:139], v176 offset:6144
    ds_read_b128 v[116:119], v177 offset:0
    ds_read_b128 v[132:135], v177 offset:4096
    ds_read_b128 v[124:127], v177 offset:2048
    ds_read_b128 v[140:143], v177 offset:6144
    s_add_u32 m0, s35, 57344
    s_add_u32 s32, s32, 57344
    buffer_load_dwordx4 v250, s[40:43], s32 offen lds
    s_add_u32 m0, s35, 61440
    s_nop 0
    buffer_load_dwordx4 v250, s[44:47], s32 offen lds
    s_add_u32 m0, s35, 65536
    s_add_u32 s32, s32, 57344
    buffer_load_dwordx4 v250, s[40:43], s32 offen lds
    s_add_u32 m0, s35, 69632
    s_nop 0
    buffer_load_dwordx4 v250, s[44:47], s32 offen lds
    s_add_u32 m0, s35, 73728
    s_add_u32 s32, s32, 57344
    buffer_load_dwordx4 v250, s[40:43], s32 offen lds
    s_add_u32 m0, s35, 77824
    s_nop 0
    buffer_load_dwordx4 v250, s[44:47], s32 offen lds
    s_waitcnt lgkmcnt(6)
    v_mfma_f32_16x16x32_bf16 v[144:147], v[112:115], v[32:35], 0
    v_mfma_f32_16x16x32_bf16 v[152:155], v[128:131], v[32:35], 0
    v_mfma_f32_16x16x32_bf16 v[144:147], v[128:131], v[40:43], v[144:147]
    v_mfma_f32_16x16x32_bf16 v[152:155], v[112:115], v[48:51], v[152:155]
    s_waitcnt lgkmcnt(4)
    v_mfma_f32_16x16x32_bf16 v[148:151], v[120:123], v[32:35], 0
    v_mfma_f32_16x16x32_bf16 v[156:159], v[136:139], v[32:35], 0
    v_mfma_f32_16x16x32_bf16 v[148:151], v[136:139], v[40:43], v[148:151]
    v_mfma_f32_16x16x32_bf16 v[156:159], v[120:123], v[48:51], v[156:159]
    s_waitcnt lgkmcnt(2)
    v_mfma_f32_16x16x32_bf16 v[144:147], v[116:119], v[36:39], v[144:147]
    v_mfma_f32_16x16x32_bf16 v[152:155], v[132:135], v[36:39], v[152:155]
    v_mfma_f32_16x16x32_bf16 v[144:147], v[132:135], v[44:47], v[144:147]
    v_mfma_f32_16x16x32_bf16 v[152:155], v[116:119], v[52:55], v[152:155]
    s_waitcnt lgkmcnt(0)
    v_mfma_f32_16x16x32_bf16 v[148:151], v[124:127], v[36:39], v[148:151]
    v_mfma_f32_16x16x32_bf16 v[156:159], v[140:143], v[36:39], v[156:159]
    v_mfma_f32_16x16x32_bf16 v[148:151], v[140:143], v[44:47], v[148:151]
    v_mfma_f32_16x16x32_bf16 v[156:159], v[124:127], v[52:55], v[156:159]
    s_waitcnt vmcnt(12)
    v_lshlrev_b32 v184, 16, v200
    v_and_b32 v192, 0xffff0000, v200
    v_lshlrev_b32 v185, 16, v201
    v_and_b32 v193, 0xffff0000, v201
    v_lshlrev_b32 v186, 16, v202
    v_and_b32 v194, 0xffff0000, v202
    v_lshlrev_b32 v187, 16, v203
    v_and_b32 v195, 0xffff0000, v203
    v_lshlrev_b32 v188, 16, v204
    v_and_b32 v196, 0xffff0000, v204
    v_lshlrev_b32 v189, 16, v205
    v_and_b32 v197, 0xffff0000, v205
    v_lshlrev_b32 v190, 16, v206
    v_and_b32 v198, 0xffff0000, v206
    v_lshlrev_b32 v191, 16, v207
    v_and_b32 v199, 0xffff0000, v207
    v_pk_mul_f32 v[160:161], v[144:145], v[80:81]
    v_pk_mul_f32 v[168:169], v[152:153], v[80:81]
    v_pk_mul_f32 v[162:163], v[146:147], v[82:83]
    v_pk_mul_f32 v[170:171], v[154:155], v[82:83]
    v_pk_mul_f32 v[164:165], v[148:149], v[84:85]
    v_pk_mul_f32 v[172:173], v[156:157], v[84:85]
    v_pk_mul_f32 v[166:167], v[150:151], v[86:87]
    v_pk_mul_f32 v[174:175], v[158:159], v[86:87]
    v_pk_fma_f32 v[160:161], v[152:153], v[88:89], v[160:161]
    v_pk_fma_f32 v[168:169], v[144:145], v[88:89], v[168:169] neg_lo:[1,0,0] neg_hi:[1,0,0]
    v_pk_fma_f32 v[162:163], v[154:155], v[90:91], v[162:163]
    v_pk_fma_f32 v[170:171], v[146:147], v[90:91], v[170:171] neg_lo:[1,0,0] neg_hi:[1,0,0]
    v_pk_fma_f32 v[164:165], v[156:157], v[92:93], v[164:165]
    v_pk_fma_f32 v[172:173], v[148:149], v[92:93], v[172:173] neg_lo:[1,0,0] neg_hi:[1,0,0]
    v_pk_fma_f32 v[166:167], v[158:159], v[94:95], v[166:167]
    v_pk_fma_f32 v[174:175], v[150:151], v[94:95], v[174:175] neg_lo:[1,0,0] neg_hi:[1,0,0]
    v_cvt_pk_bf16_f32 v176, v160, v161
    v_cvt_pk_bf16_f32 v180, v168, v169
    v_cvt_pk_bf16_f32 v177, v162, v163
    v_cvt_pk_bf16_f32 v181, v170, v171
    v_cvt_pk_bf16_f32 v178, v164, v165
    v_cvt_pk_bf16_f32 v182, v172, v173
    v_cvt_pk_bf16_f32 v179, v166, v167
    v_cvt_pk_bf16_f32 v183, v174, v175
    s_nop 0
    v_mfma_f32_16x16x32_bf16 v[144:147], v[56:59], v[176:179], 0
    v_mfma_f32_16x16x32_bf16 v[152:155], v[56:59], v[180:183], 0
    v_mfma_f32_16x16x32_bf16 v[144:147], v[64:67], v[180:183], v[144:147]
    v_mfma_f32_16x16x32_bf16 v[152:155], v[72:75], v[176:179], v[152:155]
    v_mfma_f32_16x16x32_bf16 v[148:151], v[60:63], v[176:179], 0
    v_mfma_f32_16x16x32_bf16 v[156:159], v[60:63], v[180:183], 0
    v_mfma_f32_16x16x32_bf16 v[148:151], v[68:71], v[180:183], v[148:151]
    v_mfma_f32_16x16x32_bf16 v[156:159], v[76:79], v[176:179], v[156:159]
    s_add_u32 m0, s35, 81920
    s_add_u32 s32, s32, 57344
    buffer_load_dwordx4 v250, s[40:43], s32 offen lds
    s_add_u32 m0, s35, 86016
    s_nop 0
    buffer_load_dwordx4 v250, s[44:47], s32 offen lds
    s_add_u32 m0, s35, 90112
    s_add_u32 s32, s32, 57344
    buffer_load_dwordx4 v250, s[40:43], s32 offen lds
    s_add_u32 m0, s35, 94208
    s_nop 0
    buffer_load_dwordx4 v250, s[44:47], s32 offen lds
    v_pk_mul_f32 v[160:161], v[144:145], v[184:185]
    v_pk_mul_f32 v[168:169], v[152:153], v[184:185]
    v_pk_mul_f32 v[162:163], v[146:147], v[186:187]
    v_pk_mul_f32 v[170:171], v[154:155], v[186:187]
    v_pk_mul_f32 v[164:165], v[148:149], v[188:189]
    v_pk_mul_f32 v[172:173], v[156:157], v[188:189]
    v_pk_mul_f32 v[166:167], v[150:151], v[190:191]
    v_pk_mul_f32 v[174:175], v[158:159], v[190:191]
    v_pk_fma_f32 v[160:161], v[152:153], v[192:193], v[160:161] neg_lo:[1,0,0] neg_hi:[1,0,0]
    v_pk_fma_f32 v[168:169], v[144:145], v[192:193], v[168:169]
    v_pk_fma_f32 v[162:163], v[154:155], v[194:195], v[162:163] neg_lo:[1,0,0] neg_hi:[1,0,0]
    v_pk_fma_f32 v[170:171], v[146:147], v[194:195], v[170:171]
    v_pk_fma_f32 v[164:165], v[156:157], v[196:197], v[164:165] neg_lo:[1,0,0] neg_hi:[1,0,0]
    v_pk_fma_f32 v[172:173], v[148:149], v[196:197], v[172:173]
    v_pk_fma_f32 v[166:167], v[158:159], v[198:199], v[166:167] neg_lo:[1,0,0] neg_hi:[1,0,0]
    v_pk_fma_f32 v[174:175], v[150:151], v[198:199], v[174:175]
    v_cvt_pk_bf16_f32 v176, v160, v161
    v_cvt_pk_bf16_f32 v180, v168, v169
    v_cvt_pk_bf16_f32 v177, v162, v163
    v_cvt_pk_bf16_f32 v181, v170, v171
    v_cvt_pk_bf16_f32 v178, v164, v165
    v_cvt_pk_bf16_f32 v182, v172, v173
    v_cvt_pk_bf16_f32 v179, v166, v167
    v_cvt_pk_bf16_f32 v183, v174, v175
    s_nop 0
    v_mfma_f32_16x16x32_bf16 v[144:147], v[176:179], v[56:59], 0
    v_mfma_f32_16x16x32_bf16 v[152:155], v[180:183], v[56:59], 0
    v_mfma_f32_16x16x32_bf16 v[144:147], v[180:183], v[72:75], v[144:147]
    v_mfma_f32_16x16x32_bf16 v[152:155], v[176:179], v[64:67], v[152:155]
    v_mfma_f32_16x16x32_bf16 v[148:151], v[176:179], v[60:63], 0
    v_mfma_f32_16x16x32_bf16 v[156:159], v[180:183], v[60:63], 0
    v_mfma_f32_16x16x32_bf16 v[148:151], v[180:183], v[76:79], v[148:151]
    v_mfma_f32_16x16x32_bf16 v[156:159], v[176:179], v[68:71], v[156:159]
    s_add_u32 m0, s35, 98304
    s_add_u32 s32, s32, 57344
    buffer_load_dwordx4 v250, s[40:43], s32 offen lds
    s_add_u32 m0, s35, 102400
    s_nop 0
    buffer_load_dwordx4 v250, s[44:47], s32 offen lds
    s_add_u32 m0, s35, 106496
    s_add_u32 s32, s32, 57344
    buffer_load_dwordx4 v250, s[40:43], s32 offen lds
    s_add_u32 m0, s35, 110592
    s_nop 0
    buffer_load_dwordx4 v250, s[44:47], s32 offen lds
    v_pk_mul_f32 v[160:161], v[144:145], v[96:97]
    v_pk_mul_f32 v[168:169], v[152:153], v[96:97]
    v_pk_mul_f32 v[162:163], v[146:147], v[98:99]
    v_pk_mul_f32 v[170:171], v[154:155], v[98:99]
    v_pk_mul_f32 v[164:165], v[148:149], v[100:101]
    v_pk_mul_f32 v[172:173], v[156:157], v[100:101]
    v_pk_mul_f32 v[166:167], v[150:151], v[102:103]
    v_pk_mul_f32 v[174:175], v[158:159], v[102:103]
    v_pk_fma_f32 v[160:161], v[152:153], v[104:105], v[160:161] neg_lo:[1,0,0] neg_hi:[1,0,0]
    v_pk_fma_f32 v[168:169], v[144:145], v[104:105], v[168:169]
    v_pk_fma_f32 v[162:163], v[154:155], v[106:107], v[162:163] neg_lo:[1,0,0] neg_hi:[1,0,0]
    v_pk_fma_f32 v[170:171], v[146:147], v[106:107], v[170:171]
    v_pk_fma_f32 v[164:165], v[156:157], v[108:109], v[164:165] neg_lo:[1,0,0] neg_hi:[1,0,0]
    v_pk_fma_f32 v[172:173], v[148:149], v[108:109], v[172:173]
    v_pk_fma_f32 v[166:167], v[158:159], v[110:111], v[166:167] neg_lo:[1,0,0] neg_hi:[1,0,0]
    v_pk_fma_f32 v[174:175], v[150:151], v[110:111], v[174:175]
    v_cvt_pk_bf16_f32 v176, v160, v161
    v_cvt_pk_bf16_f32 v180, v168, v169
    v_cvt_pk_bf16_f32 v177, v162, v163
    v_cvt_pk_bf16_f32 v181, v170, v171
    v_cvt_pk_bf16_f32 v178, v164, v165
    v_cvt_pk_bf16_f32 v182, v172, v173
    v_cvt_pk_bf16_f32 v179, v166, v167
    v_cvt_pk_bf16_f32 v183, v174, v175
    ds_write_b64 v208, v[176:177] offset:8192
    ds_write_b64 v208, v[178:179] offset:10240
    ds_write_b64 v208, v[180:181] offset:12288
    ds_write_b64 v208, v[182:183] offset:14336
    s_waitcnt lgkmcnt(0)
    s_barrier
    ds_read_b128 v[112:115], v3 offset:8192
    ds_read_b128 v[128:131], v3 offset:12288
    ds_read_b128 v[120:123], v3 offset:10240
    ds_read_b128 v[136:139], v3 offset:14336
    ds_read_b128 v[116:119], v3 offset:9216
    ds_read_b128 v[132:135], v3 offset:13312
    ds_read_b128 v[124:127], v3 offset:11264
    ds_read_b128 v[140:143], v3 offset:15360
    s_cmp_ge_u32 s2, 112
    s_cselect_b32 s54, s54, 0
    s_waitcnt lgkmcnt(6)
    v_mfma_f32_16x16x32_bf16 v[144:147], v[112:115], v[32:35], 0
    v_mfma_f32_16x16x32_bf16 v[152:155], v[128:131], v[32:35], 0
    v_mfma_f32_16x16x32_bf16 v[144:147], v[128:131], v[48:51], v[144:147]
    v_mfma_f32_16x16x32_bf16 v[152:155], v[112:115], v[40:43], v[152:155]
    s_waitcnt lgkmcnt(4)
    v_mfma_f32_16x16x32_bf16 v[148:151], v[120:123], v[32:35], 0
    v_mfma_f32_16x16x32_bf16 v[156:159], v[136:139], v[32:35], 0
    v_mfma_f32_16x16x32_bf16 v[148:151], v[136:139], v[48:51], v[148:151]
    v_mfma_f32_16x16x32_bf16 v[156:159], v[120:123], v[40:43], v[156:159]
    s_waitcnt lgkmcnt(2)
    v_mfma_f32_16x16x32_bf16 v[144:147], v[116:119], v[36:39], v[144:147]
    v_mfma_f32_16x16x32_bf16 v[152:155], v[132:135], v[36:39], v[152:155]
    v_mfma_f32_16x16x32_bf16 v[144:147], v[132:135], v[52:55], v[144:147]
    v_mfma_f32_16x16x32_bf16 v[152:155], v[116:119], v[44:47], v[152:155]
    s_waitcnt lgkmcnt(0)
    v_mfma_f32_16x16x32_bf16 v[148:151], v[124:127], v[36:39], v[148:151]
    v_mfma_f32_16x16x32_bf16 v[156:159], v[140:143], v[36:39], v[156:159]
    v_mfma_f32_16x16x32_bf16 v[148:151], v[140:143], v[52:55], v[148:151]
    v_mfma_f32_16x16x32_bf16 v[156:159], v[124:127], v[44:47], v[156:159]
    s_nop 1
    v_cvt_pk_bf16_f32 v176, v144, v145
    v_cvt_pk_bf16_f32 v177, v146, v147
    s_nop 2
    v_cvt_pk_bf16_f32 v178, v148, v149
    v_cvt_pk_bf16_f32 v179, v150, v151
    buffer_store_dwordx4 v[176:179], v3, s[8:11], s58 offen sc1
    v_cvt_pk_bf16_f32 v180, v152, v153
    v_cvt_pk_bf16_f32 v181, v154, v155
    v_cvt_pk_bf16_f32 v182, v156, v157
    v_cvt_pk_bf16_f32 v183, v158, v159
    v_xor_b32 v180, s54, v180
    v_xor_b32 v181, s54, v181
    v_xor_b32 v182, s54, v182
    v_xor_b32 v183, s54, v183
    buffer_store_dwordx4 v[180:183], v3, s[8:11], s59 offen sc1
    v_and_b32 v6, 1, v4
    s_and_b32 s29, s20, 1
    s_lshl_b32 s29, s29, 2
    v_lshl_or_b32 v6, v6, 1, s29
    v_and_b32 v7, 7, v1
    v_xor_b32 v6, v6, v7
    v_lshrrev_b32 v8, 3, v1
    v_lshlrev_b32 v9, 12, v8
    v_lshl_add_u32 v6, v6, 4, v9
    s_lshl_b32 s28, s20, 15
    s_lshl_b32 s27, s24, 7
    s_add_u32 s51, s28, s27
    s_sub_u32 s52, s27, s28
    s_add_u32 s52, s52, 1794048
    s_bitcmp1_b32 s22, 0
    s_cselect_b32 s53, s51, s52
    s_cselect_b32 s51, s52, s51
    s_cselect_b32 s54, 0x6000, 0
    s_cselect_b32 s55, 28672, 0
    s_mov_b32 s52, 0x20000
    s_cselect_b32 s52, 0xfffe0000, s52
    v_xor_b32 v6, s54, v6
    v_lshrrev_b32 v9, 5, v1
    v_and_b32 v8, 3, v8
    v_lshl_add_u32 v8, v9, 4, v8
    v_mul_u32_u24 v8, 0x380, v8
    v_xor_b32 v7, v7, v4
    v_xor_b32 v7, s29, v7
    v_lshl_add_u32 v10, v7, 4, v8
    s_lshr_b32 s26, s24, 3
    s_lshl_b32 s26, s26, 9
    s_lshl_b32 s28, s23, 8
    s_add_u32 s26, s26, s28
    s_and_b32 s28, s21, 3
    s_lshl2_add_u32 s29, s28, s26
    s_lshl_b32 s26, s20, 5
    s_add_u32 s26, s26, s29
    s_mul_i32 s26, s26, 896
    s_lshl_b32 s28, s22, 7
    s_add_u32 s30, s26, s28
    s_add_u32 s31, s30, 114688
    v_bfe_u32 v7, v1, 3, 2
    v_bfe_u32 v8, v1, 2, 1
    v_lshlrev_b32 v8, 4, v8
    v_lshl_add_u32 v7, v7, 5, v8
    v_and_b32 v8, 3, v1
    v_add_lshl_u32 v11, v7, v8, 2
    s_lshl2_add_u32 s56, s29, 11534336
    v_lshlrev_b32 v213, 10, v1
    s_lshl2_add_u32 s57, s2, 11632640
    s_and_b32 s58, s2, 7
    s_lshl_b32 s58, s58, 10
    s_add_u32 s58, s58, 11632640
    v_min_u32 v214, 880, v3
    s_waitcnt vmcnt(0)
    s_barrier
    s_cmp_lg_u32 s20, 0
    s_cbranch_scc1 L_se_skip_11
    s_mov_b64 exec, 0xff
    buffer_store_dword v2, v213, s[8:11], s57 offen sc1
    s_mov_b64 exec, -1
L_se_skip_11:
    ds_read_b64_tr_b16 a[64:65], v252 offset:8192
    ds_read_b64_tr_b16 a[66:67], v252 offset:9216
    ds_read_b64_tr_b16 a[68:69], v252 offset:12288
    ds_read_b64_tr_b16 a[70:71], v252 offset:13312
    ds_read_b64_tr_b16 a[72:73], v252 offset:16384
    ds_read_b64_tr_b16 a[74:75], v252 offset:17408
    ds_read_b64_tr_b16 a[76:77], v252 offset:20480
    ds_read_b64_tr_b16 a[78:79], v252 offset:21504
    ds_read_b64_tr_b16 a[80:81], v252 offset:24576
    ds_read_b64_tr_b16 a[82:83], v252 offset:25600
    ds_read_b64_tr_b16 a[84:85], v252 offset:28672
    ds_read_b64_tr_b16 a[86:87], v252 offset:29696
    ds_read_b64_tr_b16 a[88:89], v251 offset:0
    ds_read_b64_tr_b16 a[90:91], v251 offset:1024
    ds_read_b64_tr_b16 a[92:93], v251 offset:4096
    ds_read_b64_tr_b16 a[94:95], v251 offset:5120
    ds_read_b64_tr_b16 a[96:97], v251 offset:8192
    ds_read_b64_tr_b16 a[98:99], v251 offset:9216
    ds_read_b64_tr_b16 a[100:101], v251 offset:12288
    ds_read_b64_tr_b16 a[102:103], v251 offset:13312
    ds_read_b64_tr_b16 a[104:105], v251 offset:16384
    ds_read_b64_tr_b16 a[106:107], v251 offset:17408
    ds_read_b64_tr_b16 a[108:109], v251 offset:20480
    ds_read_b64_tr_b16 a[110:111], v251 offset:21504
    ds_read_b64_tr_b16 a[112:113], v251 offset:24576
    ds_read_b64_tr_b16 a[114:115], v251 offset:25600
    ds_read_b64_tr_b16 a[116:117], v251 offset:28672
    ds_read_b64_tr_b16 a[118:119], v251 offset:29696
    ds_read_b64_tr_b16 a[120:121], v251 offset:32768
    ds_read_b64_tr_b16 a[122:123], v251 offset:33792
    ds_read_b64_tr_b16 a[124:125], v251 offset:36864
    ds_read_b64_tr_b16 a[126:127], v251 offset:37888
    ds_read_b64_tr_b16 a[128:129], v251 offset:40960
    ds_read_b64_tr_b16 a[130:131], v251 offset:41984
    ds_read_b64_tr_b16 a[132:133], v251 offset:45056
    ds_read_b64_tr_b16 a[134:135], v251 offset:46080
    ds_read_b64_tr_b16 a[136:137], v251 offset:49152
    ds_read_b64_tr_b16 a[138:139], v251 offset:50176
    ds_read_b64_tr_b16 a[140:141], v251 offset:53248
    ds_read_b64_tr_b16 a[142:143], v251 offset:54272
    s_add_u32 m0, s35, 114688
    s_nop 0
    buffer_load_dwordx4 v10, s[12:15], s30 offen lds
    s_add_u32 m0, s35, 118784
    s_nop 0
    buffer_load_dwordx4 v10, s[12:15], s31 offen lds
    s_waitcnt lgkmcnt(0)
    s_barrier
    s_add_u32 m0, s35, 123904
    s_add_u32 s32, s32, 57344
    buffer_load_dwordx4 v250, s[40:43], s32 offen lds
    s_lshl_b32 s26, s22, 6
    s_lshl_b32 s27, s20, 4
    s_add_u32 s26, s26, s27
    v_add_u32 v27, s26, v5
    v_cvt_f32_u32 v27, v27
    v_mul_f32 v16, 0x3b124925, v27
    v_mul_f32 v17, 0x3b924925, v27
    v_mul_f32 v18, 0x3bdb6db7, v27
    v_mul_f32 v15, 0x3d124925, v27
    v_fract_f32 v15, v15
    v_lshl_add_u32 v19, v4, 2, 1
    v_cvt_f32_u32 v19, v19
    s_add_u32 m0, s35, 128000
    s_nop 0
    buffer_load_dwordx4 v250, s[44:47], s32 offen lds
    v_mul_f32 v14, v19, v16
    v_fract_f32 v14, v14
    v_cos_f32 v24, v14
    v_sin_f32 v20, v14
    v_add_f32 v21, v14, v16
    v_add_f32 v22, v14, v17
    v_add_f32 v23, v14, v18
    v_add_f32 v14, v14, v15
    v_fract_f32 v14, v14
    v_cos_f32 v25, v21
    v_sin_f32 v21, v21
    v_cos_f32 v26, v22
    s_add_u32 m0, s35, 132096
    s_add_u32 s32, s32, 57344
    buffer_load_dwordx4 v250, s[40:43], s32 offen lds
    v_sin_f32 v22, v22
    v_cos_f32 v27, v23
    v_sin_f32 v23, v23
    v_cvt_pk_bf16_f32 v32, v24, -v20
    v_cvt_pk_bf16_f32 v33, v25, -v21
    v_cvt_pk_bf16_f32 v34, v26, -v22
    v_cvt_pk_bf16_f32 v35, v27, -v23
    v_cos_f32 v24, v14
    v_sin_f32 v20, v14
    v_add_f32 v21, v14, v16
    v_add_f32 v22, v14, v17
    v_add_f32 v23, v14, v18
    s_add_u32 m0, s35, 136192
    s_nop 0
    buffer_load_dwordx4 v250, s[44:47], s32 offen lds
    v_add_f32 v14, v14, v15
    v_fract_f32 v14, v14
    v_cos_f32 v25, v21
    v_sin_f32 v21, v21
    v_cos_f32 v26, v22
    v_sin_f32 v22, v22
    v_cos_f32 v27, v23
    v_sin_f32 v23, v23
    v_cvt_pk_bf16_f32 v36, v24, -v20
    v_cvt_pk_bf16_f32 v37, v25, -v21
    v_cvt_pk_bf16_f32 v38, v26, -v22
    v_cvt_pk_bf16_f32 v39, v27, -v23
    s_add_u32 m0, s35, 140288
    s_add_u32 s32, s32, 57344
    buffer_load_dwordx4 v250, s[40:43], s32 offen lds
    v_cos_f32 v24, v14
    v_sin_f32 v20, v14
    v_add_f32 v21, v14, v16
    v_add_f32 v22, v14, v17
    v_add_f32 v23, v14, v18
    v_add_f32 v14, v14, v15
    v_fract_f32 v14, v14
    v_cos_f32 v25, v21
    v_sin_f32 v21, v21
    v_cos_f32 v26, v22
    v_sin_f32 v22, v22
    v_cos_f32 v27, v23
    s_add_u32 m0, s35, 144384
    s_nop 0
    buffer_load_dwordx4 v250, s[44:47], s32 offen lds
    v_sin_f32 v23, v23
    v_cvt_pk_bf16_f32 v40, v24, -v20
    v_cvt_pk_bf16_f32 v41, v25, -v21
    v_cvt_pk_bf16_f32 v42, v26, -v22
    v_cvt_pk_bf16_f32 v43, v27, -v23
    v_cos_f32 v24, v14
    v_sin_f32 v20, v14
    v_add_f32 v21, v14, v16
    v_add_f32 v22, v14, v17
    v_add_f32 v23, v14, v18
    v_add_f32 v14, v14, v15
    v_fract_f32 v14, v14
    s_add_u32 m0, s35, 148480
    s_add_u32 s32, s32, 57344
    buffer_load_dwordx4 v250, s[40:43], s32 offen lds
    v_cos_f32 v25, v21
    v_sin_f32 v21, v21
    v_cos_f32 v26, v22
    v_sin_f32 v22, v22
    v_cos_f32 v27, v23
    v_sin_f32 v23, v23
    v_cvt_pk_bf16_f32 v44, v24, -v20
    v_cvt_pk_bf16_f32 v45, v25, -v21
    v_cvt_pk_bf16_f32 v46, v26, -v22
    v_cvt_pk_bf16_f32 v47, v27, -v23
    v_cos_f32 v24, v14
    v_sin_f32 v20, v14
    s_add_u32 m0, s35, 152576
    s_nop 0
    buffer_load_dwordx4 v250, s[44:47], s32 offen lds
    v_add_f32 v21, v14, v16
    v_add_f32 v22, v14, v17
    v_add_f32 v23, v14, v18
    v_add_f32 v14, v14, v15
    v_fract_f32 v14, v14
    v_cos_f32 v25, v21
    v_sin_f32 v21, v21
    v_cos_f32 v26, v22
    v_sin_f32 v22, v22
    v_cos_f32 v27, v23
    v_sin_f32 v23, v23
    v_cvt_pk_bf16_f32 v48, v24, -v20
    s_add_u32 m0, s35, 57344
    s_add_u32 s32, s32, 57344
    buffer_load_dwordx4 v250, s[40:43], s32 offen lds
    v_cvt_pk_bf16_f32 v49, v25, -v21
    v_cvt_pk_bf16_f32 v50, v26, -v22
    v_cvt_pk_bf16_f32 v51, v27, -v23
    v_cos_f32 v24, v14
    v_sin_f32 v20, v14
    v_add_f32 v21, v14, v16
    v_add_f32 v22, v14, v17
    v_add_f32 v23, v14, v18
    v_add_f32 v14, v14, v15
    v_fract_f32 v14, v14
    v_cos_f32 v25, v21
    v_sin_f32 v21, v21
    s_add_u32 m0, s35, 61440
    s_nop 0
    buffer_load_dwordx4 v250, s[44:47], s32 offen lds
    v_cos_f32 v26, v22
    v_sin_f32 v22, v22
    v_cos_f32 v27, v23
    v_sin_f32 v23, v23
    v_cvt_pk_bf16_f32 v52, v24, -v20
    v_cvt_pk_bf16_f32 v53, v25, -v21
    v_cvt_pk_bf16_f32 v54, v26, -v22
    v_cvt_pk_bf16_f32 v55, v27, -v23
    v_cos_f32 v24, v14
    v_sin_f32 v20, v14
    v_add_f32 v21, v14, v16
    v_add_f32 v22, v14, v17
    s_add_u32 m0, s35, 65536
    s_add_u32 s32, s32, 57344
    buffer_load_dwordx4 v250, s[40:43], s32 offen lds
    v_add_f32 v23, v14, v18
    v_cos_f32 v25, v21
    v_sin_f32 v21, v21
    v_cos_f32 v26, v22
    v_sin_f32 v22, v22
    v_cos_f32 v27, v23
    v_sin_f32 v23, v23
    v_cvt_pk_bf16_f32 v56, v24, -v20
    v_cvt_pk_bf16_f32 v57, v25, -v21
    v_cvt_pk_bf16_f32 v58, v26, -v22
    v_cvt_pk_bf16_f32 v59, v27, -v23
    v_bfe_u32 v7, v1, 2, 2
    s_add_u32 m0, s35, 69632
    s_nop 0
    buffer_load_dwordx4 v250, s[44:47], s32 offen lds
    v_lshlrev_b32 v8, 10, v4
    v_lshl_add_u32 v8, v7, 7, v8
    v_and_b32 v9, 3, v1
    v_lshl_add_u32 v8, v9, 3, v8
    v_lshrrev_b32 v7, 1, v7
    v_and_b32 v9, 1, v4
    v_lshl_add_u32 v7, v9, 1, v7
    v_lshl_add_u32 v14, v7, 5, v8
    v_xor_b32 v15, 32, v14
    v_xor_b32 v16, 64, v14
    v_xor_b32 v17, 96, v14
    v_lshrrev_b32 v7, 5, v1
    s_lshl_b32 s26, s20, 1
    v_or_b32 v7, s26, v7
    v_bfe_u32 v8, v1, 1, 3
    v_xor_b32 v7, v7, v8
    v_and_b32 v8, 31, v1
    v_lshlrev_b32 v8, 7, v8
    v_lshl_add_u32 v7, v7, 4, v8
    v_add_u32 v18, 114688, v7
    s_add_u32 m0, s35, s55
    s_cmp_lg_u32 s20, 0
    s_cbranch_scc1 L_se_ps_14
    s_mov_b32 s50, 262144
    buffer_load_dwordx4 v[216:219], v214, s[8:11], s58 offen sc1
    buffer_load_dwordx4 v[220:223], v214, s[8:11], s58 offen sc1
L_se_pp_12:
    buffer_load_dwordx4 v[224:227], v214, s[8:11], s58 offen sc1
    s_waitcnt vmcnt(2)
    v_and_b32 v216, v216, v217
    v_and_b32 v218, v218, v219
    v_and_b32 v216, v216, v218
    v_cmp_eq_u32 vcc, 0, v216
    s_nop 0
    s_cbranch_vccz L_se_pd_13
    buffer_load_dwordx4 v[216:219], v214, s[8:11], s58 offen sc1
    s_waitcnt vmcnt(2)
    v_and_b32 v220, v220, v221
    v_and_b32 v222, v222, v223
    v_and_b32 v220, v220, v222
    v_cmp_eq_u32 vcc, 0, v220
    s_nop 0
    s_cbranch_vccz L_se_pd_13
    buffer_load_dwordx4 v[220:223], v214, s[8:11], s58 offen sc1
    s_waitcnt vmcnt(2)
    v_and_b32 v224, v224, v225
    v_and_b32 v226, v226, v227
    v_and_b32 v224, v224, v226
    v_cmp_eq_u32 vcc, 0, v224
    s_nop 0
    s_cbranch_vccz L_se_pd_13
    s_sub_u32 s50, s50, 1
    s_cmp_lg_u32 s50, 0
    s_cbranch_scc1 L_se_pp_12
L_se_pd_13:
L_se_ps_14:
    s_waitcnt vmcnt(0)
    s_barrier
    buffer_load_dwordx2 v[28:29], off, s[8:11], s33 offset:768 sc1
    buffer_load_dwordx4 v6, s[8:11], s51 offen sc1 lds
    s_add_u32 m0, m0, 4096
    s_add_u32 s51, s51, s52
    buffer_load_dwordx4 v6, s[8:11], s51 offen sc1 lds
    s_add_u32 m0, m0, 4096
    s_add_u32 s51, s51, s52
    buffer_load_dwordx4 v6, s[8:11], s51 offen sc1 lds
    s_add_u32 m0, m0, 4096
    s_add_u32 s51, s51, s52
    buffer_load_dwordx4 v6, s[8:11], s51 offen sc1 lds
    s_add_u32 m0, m0, 4096
    s_add_u32 s51, s51, s52
    buffer_load_dwordx4 v6, s[8:11], s51 offen sc1 lds
    s_add_u32 m0, m0, 4096
    s_add_u32 s51, s51, s52
    buffer_load_dwordx4 v6, s[8:11], s51 offen sc1 lds
    s_add_u32 m0, m0, 4096
    s_add_u32 s51, s51, s52
    s_cmp_eq_u32 s20, 3
    s_cselect_b32 s28, 14336, 0
    s_cmp_lg_u32 s54, 0
    s_cselect_b32 s28, s28, 0
    v_add_u32 v9, 16, v1
    v_and_b32 v9, 64, v9
    v_mad_u32_u24 v9, v9, s28, v6
    buffer_load_dwordx4 v9, s[8:11], s51 offen sc1 lds
    s_mov_b32 s57, s55
    s_sub_u32 s55, 28672, s55
    s_add_u32 m0, s35, s55
    v_xor_b32 v6, 0x6000, v6
    buffer_load_dwordx4 v6, s[8:11], s53 offen sc1 lds
    s_add_u32 m0, m0, 4096
    s_sub_u32 s53, s53, s52
    buffer_load_dwordx4 v6, s[8:11], s53 offen sc1 lds
    s_add_u32 m0, m0, 4096
    s_sub_u32 s53, s53, s52
    buffer_load_dwordx4 v6, s[8:11], s53 offen sc1 lds
    s_add_u32 m0, m0, 4096
    s_sub_u32 s53, s53, s52
    buffer_load_dwordx4 v6, s[8:11], s53 offen sc1 lds
    s_add_u32 m0, m0, 4096
    s_sub_u32 s53, s53, s52
    buffer_load_dwordx4 v6, s[8:11], s53 offen sc1 lds
    s_add_u32 m0, m0, 4096
    s_sub_u32 s53, s53, s52
    buffer_load_dwordx4 v6, s[8:11], s53 offen sc1 lds
    s_add_u32 m0, m0, 4096
    s_sub_u32 s53, s53, s52
    s_cmp_eq_u32 s20, 3
    s_cselect_b32 s28, 14336, 0
    s_cmp_eq_u32 s54, 0
    s_cselect_b32 s28, s28, 0
    v_add_u32 v9, 16, v1
    v_and_b32 v9, 64, v9
    v_mad_u32_u24 v9, v9, s28, v6
    buffer_load_dwordx4 v9, s[8:11], s53 offen sc1 lds
    buffer_load_dword v12, v11, s[8:11], s56 offen sc1
    buffer_load_dword v13, v11, s[8:11], s56 offen offset:512 sc1
    s_add_u32 m0, s35, 73728
    s_add_u32 s32, s32, 57344
    buffer_load_dwordx4 v250, s[40:43], s32 offen lds
    s_add_u32 m0, s35, 77824
    s_nop 0
    buffer_load_dwordx4 v250, s[44:47], s32 offen lds
    s_add_u32 m0, s35, 81920
    s_add_u32 s32, s32, 57344
    buffer_load_dwordx4 v250, s[40:43], s32 offen lds
    s_add_u32 m0, s35, 86016
    s_nop 0
    buffer_load_dwordx4 v250, s[44:47], s32 offen lds
    s_add_u32 m0, s35, 90112
    s_add_u32 s32, s32, 57344
    buffer_load_dwordx4 v250, s[40:43], s32 offen lds
    s_add_u32 m0, s35, 94208
    s_nop 0
    buffer_load_dwordx4 v250, s[44:47], s32 offen lds
    s_add_u32 m0, s35, 98304
    s_add_u32 s32, s32, 57344
    buffer_load_dwordx4 v250, s[40:43], s32 offen lds
    s_add_u32 m0, s35, 102400
    s_nop 0
    buffer_load_dwordx4 v250, s[44:47], s32 offen lds
    s_mov_b32 s40, s48
    s_and_b32 s41, s49, 0xffff
    s_mov_b32 s42, 1605632
    s_mov_b32 s43, 0x20000
    v_add_u32 v60, s55, v14
    v_add_u32 v14, s57, v14
    v_add_u32 v61, s55, v15
    v_add_u32 v15, s57, v15
    v_add_u32 v62, s55, v16
    v_add_u32 v16, s57, v16
    v_add_u32 v63, s55, v17
    v_add_u32 v17, s57, v17
    v_mov_b32 v64, v56
    v_mov_b32 v65, v57
    v_mov_b32 v66, v58
    v_mov_b32 v67, v59
    s_cmp_lg_u32 s57, 0
    s_cselect_b32 s58, 0xffff0000, 0
    s_cselect_b32 s59, 0x80000000, 0
    s_mov_b32 exec_lo, 0
    s_mov_b32 exec_hi, s58
    v_mov_b32 v59, 0x3f80
    s_xor_b32 exec_hi, s58, 0xffff0000
    v_mov_b32 v67, 0x3f80
    s_mov_b64 exec, -1
    s_mov_b32 s50, 262144
    s_waitcnt vmcnt(24)
L_se_cl_15:
    v_readfirstlane_b32 s52, v28
    v_readfirstlane_b32 s53, v29
    s_cmp_ge_u32 s60, 8
    s_cselect_b32 s54, s53, s52
    s_lshl_b32 s55, s60, 2
    s_lshr_b32 s54, s54, s55
    s_and_b32 s54, s54, 15
    s_cmp_eq_u32 s54, 14
    s_cbranch_scc1 L_se_fast_16
    s_lshr_b32 s54, s52, 4
    s_and_b32 s54, s54, 0x0f0f0f0f
    s_and_b32 s52, s52, 0x0f0f0f0f
    s_add_u32 s52, s52, s54
    s_lshr_b32 s54, s53, 4
    s_and_b32 s54, s54, 0x0f0f0f0f
    s_and_b32 s53, s53, 0x0f0f0f0f
    s_add_u32 s53, s53, s54
    s_add_u32 s52, s52, s53
    s_mul_i32 s52, s52, 0x01010101
    s_lshr_b32 s52, s52, 24
    s_cmp_ge_u32 s52, 14
    s_cbranch_scc1 L_se_slow_17
    s_sub_u32 s50, s50, 1
    s_cmp_eq_u32 s50, 0
    s_cbranch_scc1 L_se_slow_17
    buffer_load_dwordx2 v[28:29], off, s[8:11], s33 offset:768 sc1
    s_waitcnt vmcnt(0)
    s_branch L_se_cl_15
L_se_fast_16:
    s_waitcnt vmcnt(17)
    s_barrier
    ds_read_b64_tr_b16 v[88:89], v14 offset:0
    ds_read_b64_tr_b16 v[90:91], v14 offset:512
    ds_read_b64_tr_b16 v[92:93], v15 offset:0
    ds_read_b64_tr_b16 v[94:95], v15 offset:512
    ds_read_b64_tr_b16 v[96:97], v16 offset:0
    ds_read_b64_tr_b16 v[98:99], v16 offset:512
    ds_read_b64_tr_b16 v[100:101], v17 offset:0
    ds_read_b64_tr_b16 v[102:103], v17 offset:512
    ds_read_b64_tr_b16 v[104:105], v14 offset:4096
    ds_read_b64_tr_b16 v[106:107], v14 offset:4608
    ds_read_b64_tr_b16 v[108:109], v15 offset:4096
    ds_read_b64_tr_b16 v[110:111], v15 offset:4608
    s_waitcnt lgkmcnt(10)
    v_mfma_f32_16x16x32_bf16 v[120:123], v[32:35], v[88:91], 0
    ds_read_b64_tr_b16 v[112:113], v16 offset:4096
    ds_read_b64_tr_b16 v[114:115], v16 offset:4608
    s_waitcnt lgkmcnt(10)
    v_mfma_f32_16x16x32_bf16 v[124:127], v[32:35], v[92:95], 0
    ds_read_b64_tr_b16 v[116:117], v17 offset:4096
    ds_read_b64_tr_b16 v[118:119], v17 offset:4608
    s_waitcnt lgkmcnt(10)
    v_mfma_f32_16x16x32_bf16 v[128:131], v[32:35], v[96:99], 0
    ds_read_b64_tr_b16 v[88:89], v14 offset:8192
    ds_read_b64_tr_b16 v[90:91], v14 offset:8704
    s_waitcnt lgkmcnt(10)
    v_mfma_f32_16x16x32_bf16 v[132:135], v[32:35], v[100:103], 0
    ds_read_b64_tr_b16 v[92:93], v15 offset:8192
    ds_read_b64_tr_b16 v[94:95], v15 offset:8704
    s_waitcnt lgkmcnt(10)
    v_mfma_f32_16x16x32_bf16 v[120:123], v[36:39], v[104:107], v[120:123]
    ds_read_b64_tr_b16 v[96:97], v16 offset:8192
    ds_read_b64_tr_b16 v[98:99], v16 offset:8704
    s_waitcnt lgkmcnt(10)
    v_mfma_f32_16x16x32_bf16 v[124:127], v[36:39], v[108:111], v[124:127]
    ds_read_b64_tr_b16 v[100:101], v17 offset:8192
    ds_read_b64_tr_b16 v[102:103], v17 offset:8704
    s_waitcnt lgkmcnt(10)
    v_mfma_f32_16x16x32_bf16 v[128:131], v[36:39], v[112:115], v[128:131]
    ds_read_b64_tr_b16 v[104:105], v14 offset:12288
    ds_read_b64_tr_b16 v[106:107], v14 offset:12800
    s_waitcnt lgkmcnt(10)
    v_mfma_f32_16x16x32_bf16 v[132:135], v[36:39], v[116:119], v[132:135]
    ds_read_b64_tr_b16 v[108:109], v15 offset:12288
    ds_read_b64_tr_b16 v[110:111], v15 offset:12800
    s_waitcnt lgkmcnt(10)
    v_mfma_f32_16x16x32_bf16 v[120:123], v[40:43], v[88:91], v[120:123]
    ds_read_b64_tr_b16 v[112:113], v16 offset:12288
    ds_read_b64_tr_b16 v[114:115], v16 offset:12800
    s_waitcnt lgkmcnt(10)
    v_mfma_f32_16x16x32_bf16 v[124:127], v[40:43], v[92:95], v[124:127]
    ds_read_b64_tr_b16 v[116:117], v17 offset:12288
    ds_read_b64_tr_b16 v[118:119], v17 offset:12800
    s_waitcnt lgkmcnt(10)
    v_mfma_f32_16x16x32_bf16 v[128:131], v[40:43], v[96:99], v[128:131]
    ds_read_b64_tr_b16 v[88:89], v14 offset:16384
    ds_read_b64_tr_b16 v[90:91], v14 offset:16896
    s_waitcnt lgkmcnt(10)
    v_mfma_f32_16x16x32_bf16 v[132:135], v[40:43], v[100:103], v[132:135]
    ds_read_b64_tr_b16 v[92:93], v15 offset:16384
    ds_read_b64_tr_b16 v[94:95], v15 offset:16896
    s_waitcnt lgkmcnt(10)
    v_mfma_f32_16x16x32_bf16 v[120:123], v[44:47], v[104:107], v[120:123]
    ds_read_b64_tr_b16 v[96:97], v16 offset:16384
    ds_read_b64_tr_b16 v[98:99], v16 offset:16896
    s_waitcnt lgkmcnt(10)
    v_mfma_f32_16x16x32_bf16 v[124:127], v[44:47], v[108:111], v[124:127]
    ds_read_b64_tr_b16 v[100:101], v17 offset:16384
    ds_read_b64_tr_b16 v[102:103], v17 offset:16896
    s_waitcnt lgkmcnt(10)
    v_mfma_f32_16x16x32_bf16 v[128:131], v[44:47], v[112:115], v[128:131]
    ds_read_b64_tr_b16 v[104:105], v14 offset:20480
    ds_read_b64_tr_b16 v[106:107], v14 offset:20992
    s_waitcnt lgkmcnt(10)
    v_mfma_f32_16x16x32_bf16 v[132:135], v[44:47], v[116:119], v[132:135]
    ds_read_b64_tr_b16 v[108:109], v15 offset:20480
    ds_read_b64_tr_b16 v[110:111], v15 offset:20992
    s_waitcnt lgkmcnt(10)
    v_mfma_f32_16x16x32_bf16 v[120:123], v[48:51], v[88:91], v[120:123]
    ds_read_b64_tr_b16 v[112:113], v16 offset:20480
    ds_read_b64_tr_b16 v[114:115], v16 offset:20992
    s_waitcnt lgkmcnt(10)
    v_mfma_f32_16x16x32_bf16 v[124:127], v[48:51], v[92:95], v[124:127]
    ds_read_b64_tr_b16 v[116:117], v17 offset:20480
    ds_read_b64_tr_b16 v[118:119], v17 offset:20992
    s_waitcnt lgkmcnt(10)
    v_mfma_f32_16x16x32_bf16 v[128:131], v[48:51], v[96:99], v[128:131]
    ds_read_b64_tr_b16 v[88:89], v14 offset:24576
    ds_read_b64_tr_b16 v[90:91], v14 offset:25088
    s_waitcnt lgkmcnt(10)
    v_mfma_f32_16x16x32_bf16 v[132:135], v[48:51], v[100:103], v[132:135]
    ds_read_b64_tr_b16 v[92:93], v15 offset:24576
    ds_read_b64_tr_b16 v[94:95], v15 offset:25088
    s_waitcnt lgkmcnt(10)
    v_mfma_f32_16x16x32_bf16 v[120:123], v[52:55], v[104:107], v[120:123]
    ds_read_b64_tr_b16 v[96:97], v16 offset:24576
    ds_read_b64_tr_b16 v[98:99], v16 offset:25088
    s_waitcnt lgkmcnt(10)
    v_mfma_f32_16x16x32_bf16 v[124:127], v[52:55], v[108:111], v[124:127]
    ds_read_b64_tr_b16 v[100:101], v17 offset:24576
    ds_read_b64_tr_b16 v[102:103], v17 offset:25088
    s_waitcnt lgkmcnt(10)
    v_mfma_f32_16x16x32_bf16 v[128:131], v[52:55], v[112:115], v[128:131]
    s_waitcnt vmcnt(8)
    s_barrier
    ds_read_b64_tr_b16 v[104:105], v60 offset:0
    ds_read_b64_tr_b16 v[106:107], v60 offset:512
    s_waitcnt lgkmcnt(10)
    v_mfma_f32_16x16x32_bf16 v[132:135], v[52:55], v[116:119], v[132:135]
    ds_read_b64_tr_b16 v[108:109], v61 offset:0
    ds_read_b64_tr_b16 v[110:111], v61 offset:512
    s_waitcnt lgkmcnt(10)
    v_mfma_f32_16x16x32_bf16 v[120:123], v[56:59], v[88:91], v[120:123]
    ds_read_b64_tr_b16 v[112:113], v62 offset:0
    ds_read_b64_tr_b16 v[114:115], v62 offset:512
    s_waitcnt lgkmcnt(10)
    v_mfma_f32_16x16x32_bf16 v[124:127], v[56:59], v[92:95], v[124:127]
    ds_read_b64_tr_b16 v[116:117], v63 offset:0
    ds_read_b64_tr_b16 v[118:119], v63 offset:512
    s_waitcnt lgkmcnt(10)
    v_mfma_f32_16x16x32_bf16 v[128:131], v[56:59], v[96:99], v[128:131]
    ds_read_b64_tr_b16 v[88:89], v60 offset:4096
    ds_read_b64_tr_b16 v[90:91], v60 offset:4608
    s_waitcnt lgkmcnt(10)
    v_mfma_f32_16x16x32_bf16 v[132:135], v[56:59], v[100:103], v[132:135]
    ds_read_b64_tr_b16 v[92:93], v61 offset:4096
    ds_read_b64_tr_b16 v[94:95], v61 offset:4608
    s_waitcnt lgkmcnt(10)
    v_mfma_f32_16x16x32_bf16 v[136:139], v[32:35], v[104:107], 0
    ds_read_b64_tr_b16 v[96:97], v62 offset:4096
    ds_read_b64_tr_b16 v[98:99], v62 offset:4608
    s_waitcnt lgkmcnt(10)
    v_mfma_f32_16x16x32_bf16 v[140:143], v[32:35], v[108:111], 0
    ds_read_b64_tr_b16 v[100:101], v63 offset:4096
    ds_read_b64_tr_b16 v[102:103], v63 offset:4608
    s_waitcnt lgkmcnt(10)
    v_mfma_f32_16x16x32_bf16 v[144:147], v[32:35], v[112:115], 0
    ds_read_b64_tr_b16 v[104:105], v60 offset:8192
    ds_read_b64_tr_b16 v[106:107], v60 offset:8704
    s_waitcnt lgkmcnt(10)
    v_mfma_f32_16x16x32_bf16 v[148:151], v[32:35], v[116:119], 0
    ds_read_b64_tr_b16 v[108:109], v61 offset:8192
    ds_read_b64_tr_b16 v[110:111], v61 offset:8704
    s_waitcnt lgkmcnt(10)
    v_mfma_f32_16x16x32_bf16 v[136:139], v[36:39], v[88:91], v[136:139]
    ds_read_b64_tr_b16 v[112:113], v62 offset:8192
    ds_read_b64_tr_b16 v[114:115], v62 offset:8704
    s_waitcnt lgkmcnt(10)
    v_mfma_f32_16x16x32_bf16 v[140:143], v[36:39], v[92:95], v[140:143]
    ds_read_b64_tr_b16 v[116:117], v63 offset:8192
    ds_read_b64_tr_b16 v[118:119], v63 offset:8704
    s_waitcnt lgkmcnt(10)
    v_mfma_f32_16x16x32_bf16 v[144:147], v[36:39], v[96:99], v[144:147]
    ds_read_b64_tr_b16 v[88:89], v60 offset:12288
    ds_read_b64_tr_b16 v[90:91], v60 offset:12800
    s_waitcnt lgkmcnt(10)
    v_mfma_f32_16x16x32_bf16 v[148:151], v[36:39], v[100:103], v[148:151]
    ds_read_b64_tr_b16 v[92:93], v61 offset:12288
    ds_read_b64_tr_b16 v[94:95], v61 offset:12800
    s_waitcnt lgkmcnt(10)
    v_mfma_f32_16x16x32_bf16 v[136:139], v[40:43], v[104:107], v[136:139]
    ds_read_b64_tr_b16 v[96:97], v62 offset:12288
    ds_read_b64_tr_b16 v[98:99], v62 offset:12800
    s_waitcnt lgkmcnt(10)
    v_mfma_f32_16x16x32_bf16 v[140:143], v[40:43], v[108:111], v[140:143]
    ds_read_b64_tr_b16 v[100:101], v63 offset:12288
    ds_read_b64_tr_b16 v[102:103], v63 offset:12800
    s_waitcnt lgkmcnt(10)
    v_mfma_f32_16x16x32_bf16 v[144:147], v[40:43], v[112:115], v[144:147]
    ds_read_b64_tr_b16 v[104:105], v60 offset:16384
    ds_read_b64_tr_b16 v[106:107], v60 offset:16896
    s_waitcnt lgkmcnt(10)
    v_mfma_f32_16x16x32_bf16 v[148:151], v[40:43], v[116:119], v[148:151]
    ds_read_b64_tr_b16 v[108:109], v61 offset:16384
    ds_read_b64_tr_b16 v[110:111], v61 offset:16896
    s_waitcnt lgkmcnt(10)
    v_mfma_f32_16x16x32_bf16 v[136:139], v[44:47], v[88:91], v[136:139]
    ds_read_b64_tr_b16 v[112:113], v62 offset:16384
    ds_read_b64_tr_b16 v[114:115], v62 offset:16896
    s_waitcnt lgkmcnt(10)
    v_mfma_f32_16x16x32_bf16 v[140:143], v[44:47], v[92:95], v[140:143]
    ds_read_b64_tr_b16 v[116:117], v63 offset:16384
    ds_read_b64_tr_b16 v[118:119], v63 offset:16896
    s_waitcnt lgkmcnt(10)
    v_mfma_f32_16x16x32_bf16 v[144:147], v[44:47], v[96:99], v[144:147]
    ds_read_b64_tr_b16 v[88:89], v60 offset:20480
    ds_read_b64_tr_b16 v[90:91], v60 offset:20992
    s_waitcnt lgkmcnt(10)
    v_mfma_f32_16x16x32_bf16 v[148:151], v[44:47], v[100:103], v[148:151]
    ds_read_b64_tr_b16 v[92:93], v61 offset:20480
    ds_read_b64_tr_b16 v[94:95], v61 offset:20992
    s_waitcnt lgkmcnt(10)
    v_mfma_f32_16x16x32_bf16 v[136:139], v[48:51], v[104:107], v[136:139]
    ds_read_b64_tr_b16 v[96:97], v62 offset:20480
    ds_read_b64_tr_b16 v[98:99], v62 offset:20992
    s_waitcnt lgkmcnt(10)
    v_mfma_f32_16x16x32_bf16 v[140:143], v[48:51], v[108:111], v[140:143]
    ds_read_b64_tr_b16 v[100:101], v63 offset:20480
    ds_read_b64_tr_b16 v[102:103], v63 offset:20992
    s_waitcnt lgkmcnt(10)
    v_mfma_f32_16x16x32_bf16 v[144:147], v[48:51], v[112:115], v[144:147]
    ds_read_b64_tr_b16 v[104:105], v60 offset:24576
    ds_read_b64_tr_b16 v[106:107], v60 offset:25088
    s_waitcnt lgkmcnt(10)
    v_mfma_f32_16x16x32_bf16 v[148:151], v[48:51], v[116:119], v[148:151]
    ds_read_b64_tr_b16 v[108:109], v61 offset:24576
    ds_read_b64_tr_b16 v[110:111], v61 offset:25088
    s_waitcnt lgkmcnt(10)
    v_mfma_f32_16x16x32_bf16 v[136:139], v[52:55], v[88:91], v[136:139]
    ds_read_b64_tr_b16 v[112:113], v62 offset:24576
    ds_read_b64_tr_b16 v[114:115], v62 offset:25088
    s_waitcnt lgkmcnt(10)
    v_mfma_f32_16x16x32_bf16 v[140:143], v[52:55], v[92:95], v[140:143]
    ds_read_b64_tr_b16 v[116:117], v63 offset:24576
    ds_read_b64_tr_b16 v[118:119], v63 offset:25088
    s_waitcnt lgkmcnt(10)
    v_mfma_f32_16x16x32_bf16 v[144:147], v[52:55], v[96:99], v[144:147]
    s_waitcnt lgkmcnt(8)
    v_mfma_f32_16x16x32_bf16 v[148:151], v[52:55], v[100:103], v[148:151]
    s_waitcnt lgkmcnt(6)
    v_mfma_f32_16x16x32_bf16 v[136:139], v[64:67], v[104:107], v[136:139]
    s_waitcnt lgkmcnt(4)
    v_mfma_f32_16x16x32_bf16 v[140:143], v[64:67], v[108:111], v[140:143]
    s_waitcnt lgkmcnt(2)
    v_mfma_f32_16x16x32_bf16 v[144:147], v[64:67], v[112:115], v[144:147]
    s_waitcnt lgkmcnt(0)
    v_mfma_f32_16x16x32_bf16 v[148:151], v[64:67], v[116:119], v[148:151]
    ds_read_b128 v[20:23], v18
    ds_read_b128 v[24:27], v18 offset:4096
    s_mul_i32 s26, s24, 56
    s_lshl2_add_u32 s27, s22, s20
    s_add_u32 s26, s26, s27
    s_lshl_b32 s26, s26, 10
    s_add_u32 s26, s26, 2097152
    s_add_u32 s27, s26, 28672
    v_pk_add_f32 v[120:121], v[120:121], v[136:137] neg_hi:[0,1]
    v_pk_add_f32 v[122:123], v[122:123], v[138:139] neg_hi:[0,1]
    v_pk_add_f32 v[124:125], v[124:125], v[140:141] neg_hi:[0,1]
    v_pk_add_f32 v[126:127], v[126:127], v[142:143] neg_hi:[0,1]
    v_pk_add_f32 v[128:129], v[128:129], v[144:145] neg_hi:[0,1]
    v_pk_add_f32 v[130:131], v[130:131], v[146:147] neg_hi:[0,1]
    v_pk_add_f32 v[132:133], v[132:133], v[148:149] neg_hi:[0,1]
    v_pk_add_f32 v[134:135], v[134:135], v[150:151] neg_hi:[0,1]
    v_xor_b32 v121, s59, v121
    v_xor_b32 v123, s59, v123
    v_xor_b32 v125, s59, v125
    v_xor_b32 v127, s59, v127
    v_xor_b32 v129, s59, v129
    v_xor_b32 v131, s59, v131
    v_xor_b32 v133, s59, v133
    v_xor_b32 v135, s59, v135
    v_permlane16_swap_b32 v120, v124
    v_permlane16_swap_b32 v121, v125
    v_permlane16_swap_b32 v122, v126
    v_permlane16_swap_b32 v123, v127
    v_permlane16_swap_b32 v128, v132
    v_permlane16_swap_b32 v129, v133
    v_permlane16_swap_b32 v130, v134
    v_permlane16_swap_b32 v131, v135
    s_waitcnt lgkmcnt(0)
    v_lshlrev_b32 v48, 16, v20
    v_and_b32 v49, 0xffff0000, v20
    v_lshlrev_b32 v50, 16, v21
    v_and_b32 v51, 0xffff0000, v21
    v_lshlrev_b32 v52, 16, v22
    v_and_b32 v53, 0xffff0000, v22
    v_lshlrev_b32 v54, 16, v23
    v_and_b32 v55, 0xffff0000, v23
    v_pk_add_f32 v[120:121], v[120:121], v[48:49]
    v_pk_add_f32 v[122:123], v[122:123], v[50:51]
    v_pk_add_f32 v[124:125], v[124:125], v[52:53]
    v_pk_add_f32 v[126:127], v[126:127], v[54:55]
    v_pk_add_f32 v[136:137], v[120:121], v[12:13] op_sel:[0,0] op_sel_hi:[1,0] neg_lo:[0,1] neg_hi:[0,1]
    v_pk_add_f32 v[138:139], v[122:123], v[12:13] op_sel:[0,0] op_sel_hi:[1,0] neg_lo:[0,1] neg_hi:[0,1]
    v_pk_add_f32 v[140:141], v[124:125], v[12:13] op_sel:[0,0] op_sel_hi:[1,0] neg_lo:[0,1] neg_hi:[0,1]
    v_pk_add_f32 v[142:143], v[126:127], v[12:13] op_sel:[0,0] op_sel_hi:[1,0] neg_lo:[0,1] neg_hi:[0,1]
    v_cvt_pk_bf16_f32 v40, v136, v137
    v_cvt_pk_bf16_f32 v41, v138, v139
    v_cvt_pk_bf16_f32 v42, v140, v141
    v_cvt_pk_bf16_f32 v43, v142, v143
    buffer_store_dwordx4 v[40:43], v3, s[8:11], s26 offen
    v_lshlrev_b32 v48, 16, v24
    v_and_b32 v49, 0xffff0000, v24
    v_lshlrev_b32 v50, 16, v25
    v_and_b32 v51, 0xffff0000, v25
    v_lshlrev_b32 v52, 16, v26
    v_and_b32 v53, 0xffff0000, v26
    v_lshlrev_b32 v54, 16, v27
    v_and_b32 v55, 0xffff0000, v27
    v_pk_add_f32 v[128:129], v[128:129], v[48:49]
    v_pk_add_f32 v[130:131], v[130:131], v[50:51]
    v_pk_add_f32 v[132:133], v[132:133], v[52:53]
    v_pk_add_f32 v[134:135], v[134:135], v[54:55]
    v_pk_add_f32 v[144:145], v[128:129], v[12:13] op_sel:[0,1] op_sel_hi:[1,1] neg_lo:[0,1] neg_hi:[0,1]
    v_pk_add_f32 v[146:147], v[130:131], v[12:13] op_sel:[0,1] op_sel_hi:[1,1] neg_lo:[0,1] neg_hi:[0,1]
    v_pk_add_f32 v[148:149], v[132:133], v[12:13] op_sel:[0,1] op_sel_hi:[1,1] neg_lo:[0,1] neg_hi:[0,1]
    v_pk_add_f32 v[150:151], v[134:135], v[12:13] op_sel:[0,1] op_sel_hi:[1,1] neg_lo:[0,1] neg_hi:[0,1]
    v_cvt_pk_bf16_f32 v44, v144, v145
    v_cvt_pk_bf16_f32 v45, v146, v147
    v_cvt_pk_bf16_f32 v46, v148, v149
    v_cvt_pk_bf16_f32 v47, v150, v151
    buffer_store_dwordx4 v[44:47], v3, s[8:11], s27 offen
    s_waitcnt vmcnt(2)
    s_barrier
    ds_read_b64_tr_b16 a[144:145], v252 offset:0
    ds_read_b64_tr_b16 a[146:147], v252 offset:1024
    ds_read_b64_tr_b16 a[148:149], v252 offset:4096
    ds_read_b64_tr_b16 a[150:151], v252 offset:5120
    ds_read_b64_tr_b16 a[152:153], v252 offset:8192
    ds_read_b64_tr_b16 a[154:155], v252 offset:9216
    ds_read_b64_tr_b16 a[156:157], v252 offset:12288
    ds_read_b64_tr_b16 a[158:159], v252 offset:13312
    ds_read_b64_tr_b16 a[160:161], v252 offset:16384
    ds_read_b64_tr_b16 a[162:163], v252 offset:17408
    ds_read_b64_tr_b16 a[164:165], v252 offset:20480
    ds_read_b64_tr_b16 a[166:167], v252 offset:21504
    ds_read_b64_tr_b16 a[168:169], v252 offset:24576
    ds_read_b64_tr_b16 a[170:171], v252 offset:25600
    ds_read_b64_tr_b16 a[172:173], v252 offset:28672
    ds_read_b64_tr_b16 a[174:175], v252 offset:29696
    ds_read_b64_tr_b16 a[176:177], v251 offset:0
    ds_read_b64_tr_b16 a[178:179], v251 offset:1024
    ds_read_b64_tr_b16 a[180:181], v251 offset:4096
    ds_read_b64_tr_b16 a[182:183], v251 offset:5120
    ds_read_b64_tr_b16 a[184:185], v251 offset:8192
    ds_read_b64_tr_b16 a[186:187], v251 offset:9216
    ds_read_b64_tr_b16 a[188:189], v251 offset:12288
    ds_read_b64_tr_b16 a[190:191], v251 offset:13312
    ds_read_b64_tr_b16 a[192:193], v251 offset:16384
    ds_read_b64_tr_b16 a[194:195], v251 offset:17408
    ds_read_b64_tr_b16 a[196:197], v251 offset:20480
    ds_read_b64_tr_b16 a[198:199], v251 offset:21504
    ds_read_b64_tr_b16 a[200:201], v251 offset:24576
    ds_read_b64_tr_b16 a[202:203], v251 offset:25600
    ds_read_b64_tr_b16 a[204:205], v251 offset:28672
    ds_read_b64_tr_b16 a[206:207], v251 offset:29696
    ds_read_b64_tr_b16 a[208:209], v251 offset:32768
    ds_read_b64_tr_b16 a[210:211], v251 offset:33792
    ds_read_b64_tr_b16 a[212:213], v251 offset:36864
    ds_read_b64_tr_b16 a[214:215], v251 offset:37888
    ds_read_b64_tr_b16 a[216:217], v251 offset:40960
    ds_read_b64_tr_b16 a[218:219], v251 offset:41984
    ds_read_b64_tr_b16 a[220:221], v251 offset:45056
    ds_read_b64_tr_b16 a[222:223], v251 offset:46080
    s_waitcnt vmcnt(0)
    s_waitcnt lgkmcnt(0)
    buffer_store_dword v2, off, s[8:11], s39 offset:0
    v_cvt_pk_bf16_f32 v32, v120, v121
    v_cvt_pk_bf16_f32 v33, v122, v123
    v_cvt_pk_bf16_f32 v34, v124, v125
    v_cvt_pk_bf16_f32 v35, v126, v127
    ds_write_b128 v18, v[32:35] offset:0
    v_cvt_pk_bf16_f32 v36, v128, v129
    v_cvt_pk_bf16_f32 v37, v130, v131
    v_cvt_pk_bf16_f32 v38, v132, v133
    v_cvt_pk_bf16_f32 v39, v134, v135
    ds_write_b128 v18, v[36:39] offset:4096
    v_mul_f32 v12, v136, v136
    v_mul_f32 v13, v144, v144
    v_fmac_f32 v12, v137, v137
    v_fmac_f32 v13, v145, v145
    v_fmac_f32 v12, v138, v138
    v_fmac_f32 v13, v146, v146
    v_fmac_f32 v12, v139, v139
    v_fmac_f32 v13, v147, v147
    v_fmac_f32 v12, v140, v140
    v_fmac_f32 v13, v148, v148
    v_fmac_f32 v12, v141, v141
    v_fmac_f32 v13, v149, v149
    v_fmac_f32 v12, v142, v142
    v_fmac_f32 v13, v150, v150
    v_fmac_f32 v12, v143, v143
    v_fmac_f32 v13, v151, v151
    s_lshl_b32 s26, s20, 8
    s_add_u32 s26, s26, 122880
    v_add_u32 v7, s26, v30
    v_permlane32_swap_b32 v12, v13
    v_add_f32 v12, v12, v13
    ds_write_b32 v7, v12
    s_mul_i32 s56, s21, 114688
    s_add_u32 s56, s56, 2097152
    s_mul_i32 s51, s20, 28672
    s_and_b32 s28, s20, 1
    s_mul_i32 s28, s28, 57344
    s_lshr_b32 s26, s20, 1
    s_lshl_b32 s52, s26, 10
    s_add_u32 s52, s52, s28
    s_add_u32 s53, s56, s51
    s_add_u32 s54, s56, s52
    s_add_u32 s53, s53, s3
    s_add_u32 s54, s54, s3
    v_add_u32 v6, 57344, v3
    s_mul_i32 s61, s24, 1792
    s_add_u32 s61, s61, 11542528
    v_add_u32 v7, 122880, v30
    s_mul_i32 s36, s21, 448
    s_lshl1_add_u32 s36, s25, s36
    s_lshl_b32 s36, s36, 10
    s_add_u32 s36, s36, 4194304
    v_lshlrev_b32 v11, 12, v4
    v_lshl_add_u32 v11, v5, 4, v11
    s_lshl_b32 s55, s21, 8
    s_mul_i32 s37, s24, 224
    s_mul_i32 s28, s20, 28
    s_add_u32 s37, s37, s28
    s_lshl_b32 s37, s37, 10
    s_add_u32 s37, s37, 4194304
    s_mul_i32 s34, s20, 401408
    s_lshl_b32 s28, s22, 7
    s_add_u32 s34, s34, s28
    s_add_u32 s46, s22, s24
    s_lshl_b32 s35, s20, 13
    s_add_u32 s35, s35, 123904
    v_and_b32 v12, 1, v4
    v_and_b32 v13, 7, v1
    v_lshlrev_b32 v14, 2, v12
    v_xor_b32 v13, v13, v14
    v_lshrrev_b32 v14, 3, v1
    v_mul_u32_u24 v14, 0x380, v14
    v_lshl_add_u32 v8, v13, 4, v14
    v_bfe_u32 v13, v1, 2, 2
    v_lshrrev_b32 v14, 5, v1
    v_lshl_add_u32 v14, v14, 2, v13
    v_lshrrev_b32 v13, 1, v13
    v_lshlrev_b32 v13, 6, v13
    v_lshl_add_u32 v13, v14, 7, v13
    v_lshl_add_u32 v13, v12, 5, v13
    v_and_b32 v14, 3, v1
    v_lshl_add_u32 v13, v14, 3, v13
    v_add_u32 v9, s35, v13
    v_xor_b32 v26, 64, v9
    v_add_u32 v56, s51, v13
    v_xor_b32 v57, 64, v56
    buffer_load_dword v31, v0, s[8:11], s33 offen offset:0 sc1
    s_waitcnt vmcnt(0)
    v_cmp_eq_u32 vcc, 0, v31
    s_mov_b32 s50, 262144
    s_cbranch_vccnz L_se_poll_18
L_se_done_19:
    s_add_u32 m0, s51, 0
    s_add_u32 s28, s53, 0
    buffer_load_dwordx4 v3, s[8:11], s28 offen sc1 lds
    s_add_u32 m0, s51, 1024
    s_add_u32 s28, s53, 1024
    buffer_load_dwordx4 v3, s[8:11], s28 offen sc1 lds
    s_add_u32 m0, s51, 2048
    s_add_u32 s28, s53, 2048
    buffer_load_dwordx4 v3, s[8:11], s28 offen sc1 lds
    s_add_u32 m0, s51, 3072
    s_add_u32 s28, s53, 3072
    buffer_load_dwordx4 v3, s[8:11], s28 offen sc1 lds
    s_add_u32 m0, s52, 4096
    s_add_u32 s28, s54, 4096
    buffer_load_dwordx4 v3, s[8:11], s28 offen sc1 lds
    s_add_u32 m0, s52, 6144
    s_add_u32 s28, s54, 6144
    buffer_load_dwordx4 v3, s[8:11], s28 offen sc1 lds
    s_add_u32 m0, s52, 8192
    s_add_u32 s28, s54, 8192
    buffer_load_dwordx4 v3, s[8:11], s28 offen sc1 lds
    s_waitcnt lgkmcnt(0)
    s_waitcnt vmcnt(4)
    s_barrier
    ds_read_b128 v[32:35], v3 offset:0
    ds_read_b128 v[36:39], v3 offset:28672
    ds_read_b128 v[40:43], v6 offset:0
    ds_read_b128 v[44:47], v6 offset:28672
    s_waitcnt lgkmcnt(2)
    v_mfma_f32_32x32x16_bf16 v[128:143], a[0:3], v[32:35], 0
    ds_read_b128 v[48:51], v3 offset:1024
    s_add_u32 m0, s52, 10240
    s_add_u32 s28, s54, 10240
    v_mfma_f32_32x32x16_bf16 v[144:159], a[4:7], v[32:35], 0
    buffer_load_dwordx4 v3, s[8:11], s28 offen sc1 lds
    ds_read2st64_b32 v[12:13], v7 offset1:1
    ds_read2st64_b32 v[14:15], v7 offset0:2 offset1:3
    s_lshl_b32 s26, s22, 8
    s_add_u32 s26, s26, s61
    v_mfma_f32_32x32x16_bf16 v[192:207], a[0:3], v[36:39], 0
    ds_read_b128 v[52:55], v3 offset:29696
    s_add_u32 m0, s35, 0
    s_add_u32 s44, s22, 0
    s_and_b32 s44, s44, 3
    s_mul_i32 s44, s44, 100352
    s_add_u32 s44, s44, s34
    v_mfma_f32_32x32x16_bf16 v[208:223], a[4:7], v[36:39], 0
    buffer_load_dwordx4 v8, s[40:43], s44 offen lds
    s_waitcnt lgkmcnt(4)
    v_mfma_f32_32x32x16_bf16 v[160:175], a[0:3], v[40:43], 0
    ds_read_b128 v[32:35], v6 offset:1024
    s_add_u32 m0, s52, 12288
    s_add_u32 s28, s54, 12288
    v_mfma_f32_32x32x16_bf16 v[176:191], a[4:7], v[40:43], 0
    buffer_load_dwordx4 v3, s[8:11], s28 offen sc1 lds
    v_mfma_f32_32x32x16_bf16 v[224:239], a[0:3], v[44:47], 0
    ds_read_b128 v[36:39], v6 offset:29696
    s_add_u32 m0, s35, 1024
    s_add_u32 s44, s44, 7168
    v_mfma_f32_32x32x16_bf16 v[240:255], a[4:7], v[44:47], 0
    buffer_load_dwordx4 v8, s[40:43], s44 offen lds
    s_waitcnt lgkmcnt(2)
    v_mfma_f32_32x32x16_bf16 v[128:143], a[8:11], v[48:51], v[128:143]
    ds_read_b128 v[40:43], v3 offset:2048
    s_add_u32 m0, s52, 14336
    s_add_u32 s28, s54, 14336
    v_mfma_f32_32x32x16_bf16 v[144:159], a[12:15], v[48:51], v[144:159]
    buffer_load_dwordx4 v3, s[8:11], s28 offen sc1 lds
    v_add_f32 v12, v12, v13
    v_add_f32 v14, v14, v15
    v_add_f32 v12, v12, v14
    buffer_store_dword v12, v30, s[8:11], s26 offen
    v_mfma_f32_32x32x16_bf16 v[192:207], a[8:11], v[52:55], v[192:207]
    ds_read_b128 v[44:47], v3 offset:30720
    s_add_u32 m0, s52, 16384
    s_add_u32 s28, s54, 16384
    v_mfma_f32_32x32x16_bf16 v[208:223], a[12:15], v[52:55], v[208:223]
    buffer_load_dwordx4 v3, s[8:11], s28 offen sc1 lds
    s_waitcnt lgkmcnt(2)
    v_mfma_f32_32x32x16_bf16 v[160:175], a[8:11], v[32:35], v[160:175]
    ds_read_b128 v[48:51], v6 offset:2048
    s_add_u32 m0, s52, 18432
    s_add_u32 s28, s54, 18432
    v_mfma_f32_32x32x16_bf16 v[176:191], a[12:15], v[32:35], v[176:191]
    buffer_load_dwordx4 v3, s[8:11], s28 offen sc1 lds
    v_mfma_f32_32x32x16_bf16 v[224:239], a[8:11], v[36:39], v[224:239]
    ds_read_b128 v[52:55], v6 offset:30720
    s_add_u32 m0, s35, 2048
    s_add_u32 s44, s44, 7168
    v_mfma_f32_32x32x16_bf16 v[240:255], a[12:15], v[36:39], v[240:255]
    buffer_load_dwordx4 v8, s[40:43], s44 offen lds
    s_waitcnt vmcnt(9)
    s_barrier
    s_waitcnt lgkmcnt(2)
    v_mfma_f32_32x32x16_bf16 v[128:143], a[16:19], v[40:43], v[128:143]
    ds_read_b128 v[32:35], v3 offset:3072
    s_add_u32 m0, s52, 20480
    s_add_u32 s28, s54, 20480
    v_mfma_f32_32x32x16_bf16 v[144:159], a[20:23], v[40:43], v[144:159]
    buffer_load_dwordx4 v3, s[8:11], s28 offen sc1 lds
    v_mfma_f32_32x32x16_bf16 v[192:207], a[16:19], v[44:47], v[192:207]
    ds_read_b128 v[36:39], v3 offset:31744
    s_add_u32 m0, s35, 3072
    s_add_u32 s44, s44, 7168
    v_mfma_f32_32x32x16_bf16 v[208:223], a[20:23], v[44:47], v[208:223]
    buffer_load_dwordx4 v8, s[40:43], s44 offen lds
    s_waitcnt lgkmcnt(2)
    v_mfma_f32_32x32x16_bf16 v[160:175], a[16:19], v[48:51], v[160:175]
    ds_read_b128 v[40:43], v6 offset:3072
    s_add_u32 m0, s52, 22528
    s_add_u32 s28, s54, 22528
    v_mfma_f32_32x32x16_bf16 v[176:191], a[20:23], v[48:51], v[176:191]
    buffer_load_dwordx4 v3, s[8:11], s28 offen sc1 lds
    v_mfma_f32_32x32x16_bf16 v[224:239], a[16:19], v[52:55], v[224:239]
    ds_read_b128 v[44:47], v6 offset:31744
    s_waitcnt vmcnt(10)
    ds_read_b64_tr_b16 a[224:225], v9 offset:0
    s_add_u32 m0, s52, 24576
    s_add_u32 s28, s54, 24576
    v_mfma_f32_32x32x16_bf16 v[240:255], a[20:23], v[52:55], v[240:255]
    buffer_load_dwordx4 v3, s[8:11], s28 offen sc1 lds
    ds_read_b64_tr_b16 a[228:229], v26 offset:0
    s_waitcnt lgkmcnt(4)
    v_mfma_f32_32x32x16_bf16 v[128:143], a[24:27], v[32:35], v[128:143]
    ds_read_b128 v[48:51], v3 offset:4096
    s_add_u32 m0, s52, 26624
    s_add_u32 s28, s54, 26624
    v_mfma_f32_32x32x16_bf16 v[144:159], a[28:31], v[32:35], v[144:159]
    buffer_load_dwordx4 v3, s[8:11], s28 offen sc1 lds
    v_mfma_f32_32x32x16_bf16 v[192:207], a[24:27], v[36:39], v[192:207]
    ds_read_b128 v[52:55], v6 offset:4096
    s_waitcnt vmcnt(10)
    ds_read_b64_tr_b16 a[226:227], v9 offset:1024
    s_add_u32 m0, s35, 4096
    s_add_u32 s44, s44, 7168
    v_mfma_f32_32x32x16_bf16 v[208:223], a[28:31], v[36:39], v[208:223]
    buffer_load_dwordx4 v8, s[40:43], s44 offen lds
    ds_read_b64_tr_b16 a[230:231], v26 offset:1024
    s_waitcnt lgkmcnt(6)
    v_mfma_f32_32x32x16_bf16 v[160:175], a[24:27], v[40:43], v[160:175]
    ds_read_b128 v[32:35], v3 offset:5120
    s_add_u32 m0, s52, 32768
    s_add_u32 s28, s54, 32768
    v_mfma_f32_32x32x16_bf16 v[176:191], a[28:31], v[40:43], v[176:191]
    buffer_load_dwordx4 v3, s[8:11], s28 offen sc1 lds
    v_mfma_f32_32x32x16_bf16 v[224:239], a[24:27], v[44:47], v[224:239]
    ds_read_b128 v[36:39], v6 offset:5120
    s_add_u32 m0, s35, 5120
    s_add_u32 s44, s44, 7168
    v_mfma_f32_32x32x16_bf16 v[240:255], a[28:31], v[44:47], v[240:255]
    buffer_load_dwordx4 v8, s[40:43], s44 offen lds
    s_waitcnt lgkmcnt(4)
    v_mfma_f32_32x32x16_bf16 v[128:143], a[32:35], v[48:51], v[128:143]
    ds_read_b128 v[40:43], v3 offset:6144
    s_add_u32 m0, s35, 0
    s_add_u32 s44, s44, 7168
    v_mfma_f32_32x32x16_bf16 v[144:159], a[36:39], v[48:51], v[144:159]
    buffer_load_dwordx4 v8, s[40:43], s44 offen lds
    v_mfma_f32_32x32x16_bf16 v[160:175], a[32:35], v[52:55], v[160:175]
    ds_read_b128 v[44:47], v6 offset:6144
    s_waitcnt vmcnt(9)
    ds_read_b64_tr_b16 a[232:233], v9 offset:2048
    s_add_u32 m0, s52, 34816
    s_add_u32 s28, s54, 34816
    v_mfma_f32_32x32x16_bf16 v[176:191], a[36:39], v[52:55], v[176:191]
    buffer_load_dwordx4 v3, s[8:11], s28 offen sc1 lds
    ds_read_b64_tr_b16 a[236:237], v26 offset:2048
    s_barrier
    s_waitcnt lgkmcnt(4)
    v_mfma_f32_32x32x16_bf16 v[128:143], a[40:43], v[32:35], v[128:143]
    ds_read_b128 v[48:51], v3 offset:7168
    s_add_u32 m0, s35, 1024
    s_add_u32 s44, s44, 7168
    v_mfma_f32_32x32x16_bf16 v[144:159], a[44:47], v[32:35], v[144:159]
    buffer_load_dwordx4 v8, s[40:43], s44 offen lds
    v_mfma_f32_32x32x16_bf16 v[160:175], a[40:43], v[36:39], v[160:175]
    ds_read_b128 v[52:55], v6 offset:7168
    s_waitcnt vmcnt(9)
    ds_read_b64_tr_b16 a[234:235], v9 offset:3072
    s_add_u32 m0, s35, 6144
    s_add_u32 s44, s44, 7168
    v_mfma_f32_32x32x16_bf16 v[176:191], a[44:47], v[36:39], v[176:191]
    buffer_load_dwordx4 v8, s[40:43], s44 offen lds
    ds_read_b64_tr_b16 a[238:239], v26 offset:3072
    s_waitcnt lgkmcnt(6)
    v_mfma_f32_32x32x16_bf16 v[128:143], a[48:51], v[40:43], v[128:143]
    ds_read_b128 v[32:35], v3 offset:8192
    s_add_u32 m0, s52, 36864
    s_add_u32 s28, s54, 36864
    v_mfma_f32_32x32x16_bf16 v[144:159], a[52:55], v[40:43], v[144:159]
    buffer_load_dwordx4 v3, s[8:11], s28 offen sc1 lds
    v_mfma_f32_32x32x16_bf16 v[160:175], a[48:51], v[44:47], v[160:175]
    ds_read_b128 v[36:39], v6 offset:8192
    s_add_u32 m0, s35, 7168
    s_add_u32 s44, s44, 7168
    v_mfma_f32_32x32x16_bf16 v[176:191], a[52:55], v[44:47], v[176:191]
    buffer_load_dwordx4 v8, s[40:43], s44 offen lds
    s_waitcnt lgkmcnt(4)
    v_mfma_f32_32x32x16_bf16 v[128:143], a[56:59], v[48:51], v[128:143]
    ds_read_b128 v[40:43], v3 offset:9216
    s_add_u32 m0, s35, 2048
    s_add_u32 s44, s44, 7168
    v_mfma_f32_32x32x16_bf16 v[144:159], a[60:63], v[48:51], v[144:159]
    buffer_load_dwordx4 v8, s[40:43], s44 offen lds
    v_mfma_f32_32x32x16_bf16 v[160:175], a[56:59], v[52:55], v[160:175]
    ds_read_b128 v[44:47], v6 offset:9216
    s_waitcnt vmcnt(9)
    ds_read_b64_tr_b16 a[240:241], v9 offset:4096
    s_add_u32 m0, s52, 38912
    s_add_u32 s28, s54, 38912
    v_mfma_f32_32x32x16_bf16 v[176:191], a[60:63], v[52:55], v[176:191]
    buffer_load_dwordx4 v3, s[8:11], s28 offen sc1 lds
    ds_read_b64_tr_b16 a[244:245], v26 offset:4096
    s_barrier
    s_waitcnt lgkmcnt(4)
    v_mfma_f32_32x32x16_bf16 v[128:143], a[64:67], v[32:35], v[128:143]
    ds_read_b128 v[48:51], v3 offset:10240
    s_add_u32 m0, s35, 3072
    s_add_u32 s44, s44, 7168
    v_mfma_f32_32x32x16_bf16 v[144:159], a[68:71], v[32:35], v[144:159]
    buffer_load_dwordx4 v8, s[40:43], s44 offen lds
    v_mfma_f32_32x32x16_bf16 v[160:175], a[64:67], v[36:39], v[160:175]
    ds_read_b128 v[52:55], v6 offset:10240
    s_waitcnt vmcnt(9)
    ds_read_b64_tr_b16 a[242:243], v9 offset:5120
    s_add_u32 m0, s51, 0
    s_add_u32 s44, s44, 7168
    v_mfma_f32_32x32x16_bf16 v[176:191], a[68:71], v[36:39], v[176:191]
    buffer_load_dwordx4 v8, s[40:43], s44 offen lds
    ds_read_b64_tr_b16 a[246:247], v26 offset:5120
    s_waitcnt lgkmcnt(6)
    v_mfma_f32_32x32x16_bf16 v[128:143], a[72:75], v[40:43], v[128:143]
    ds_read_b128 v[32:35], v3 offset:11264
    s_waitcnt vmcnt(9)
    ds_read_b64_tr_b16 a[248:249], v9 offset:0
    s_add_u32 m0, s52, 40960
    s_add_u32 s28, s54, 40960
    v_mfma_f32_32x32x16_bf16 v[144:159], a[76:79], v[40:43], v[144:159]
    buffer_load_dwordx4 v3, s[8:11], s28 offen sc1 lds
    ds_read_b64_tr_b16 a[252:253], v26 offset:0
    v_mfma_f32_32x32x16_bf16 v[160:175], a[72:75], v[44:47], v[160:175]
    ds_read_b128 v[36:39], v6 offset:11264
    s_add_u32 m0, s51, 1024
    s_add_u32 s44, s44, 7168
    v_mfma_f32_32x32x16_bf16 v[176:191], a[76:79], v[44:47], v[176:191]
    buffer_load_dwordx4 v8, s[40:43], s44 offen lds
    s_waitcnt lgkmcnt(6)
    v_mfma_f32_32x32x16_bf16 v[128:143], a[80:83], v[48:51], v[128:143]
    ds_read_b128 v[40:43], v3 offset:12288
    s_waitcnt vmcnt(9)
    ds_read_b64_tr_b16 a[250:251], v9 offset:1024
    s_add_u32 m0, s35, 4096
    s_add_u32 s44, s22, 1
    s_and_b32 s44, s44, 3
    s_mul_i32 s44, s44, 100352
    s_add_u32 s44, s44, s34
    v_mfma_f32_32x32x16_bf16 v[144:159], a[84:87], v[48:51], v[144:159]
    buffer_load_dwordx4 v8, s[40:43], s44 offen lds
    ds_read_b64_tr_b16 a[254:255], v26 offset:1024
    v_mfma_f32_32x32x16_bf16 v[160:175], a[80:83], v[52:55], v[160:175]
    ds_read_b128 v[44:47], v6 offset:12288
    s_waitcnt vmcnt(9)
    ds_read_b64_tr_b16 v[64:65], v9 offset:6144
    s_add_u32 m0, s52, 43008
    s_add_u32 s28, s54, 43008
    v_mfma_f32_32x32x16_bf16 v[176:191], a[84:87], v[52:55], v[176:191]
    buffer_load_dwordx4 v3, s[8:11], s28 offen sc1 lds
    ds_read_b64_tr_b16 v[68:69], v26 offset:6144
    s_waitcnt lgkmcnt(6)
    v_mfma_f32_32x32x16_bf16 v[128:143], a[88:91], v[32:35], v[128:143]
    ds_read_b128 v[48:51], v3 offset:13312
    s_add_u32 m0, s35, 0
    s_add_u32 s44, s44, 7168
    v_mfma_f32_32x32x16_bf16 v[144:159], a[92:95], v[32:35], v[144:159]
    buffer_load_dwordx4 v8, s[40:43], s44 offen lds
    v_mfma_f32_32x32x16_bf16 v[160:175], a[88:91], v[36:39], v[160:175]
    ds_read_b128 v[52:55], v6 offset:13312
    s_waitcnt vmcnt(9)
    ds_read_b64_tr_b16 v[66:67], v9 offset:7168
    s_add_u32 m0, s35, 5120
    s_add_u32 s44, s44, 7168
    v_mfma_f32_32x32x16_bf16 v[176:191], a[92:95], v[36:39], v[176:191]
    buffer_load_dwordx4 v8, s[40:43], s44 offen lds
    ds_read_b64_tr_b16 v[70:71], v26 offset:7168
    s_waitcnt lgkmcnt(6)
    v_mfma_f32_32x32x16_bf16 v[128:143], a[96:99], v[40:43], v[128:143]
    ds_read_b128 v[32:35], v3 offset:14336
    s_waitcnt vmcnt(9)
    ds_read_b64_tr_b16 v[72:73], v9 offset:2048
    s_add_u32 m0, s52, 45056
    s_add_u32 s28, s54, 45056
    v_mfma_f32_32x32x16_bf16 v[144:159], a[100:103], v[40:43], v[144:159]
    buffer_load_dwordx4 v3, s[8:11], s28 offen sc1 lds
    ds_read_b64_tr_b16 v[76:77], v26 offset:2048
    v_mfma_f32_32x32x16_bf16 v[160:175], a[96:99], v[44:47], v[160:175]
    ds_read_b128 v[36:39], v6 offset:14336
    s_add_u32 m0, s35, 1024
    s_add_u32 s44, s44, 7168
    v_mfma_f32_32x32x16_bf16 v[176:191], a[100:103], v[44:47], v[176:191]
    buffer_load_dwordx4 v8, s[40:43], s44 offen lds
    s_waitcnt lgkmcnt(6)
    v_mfma_f32_32x32x16_bf16 v[128:143], a[104:107], v[48:51], v[128:143]
    ds_read_b128 v[40:43], v3 offset:15360
    s_waitcnt vmcnt(9)
    ds_read_b64_tr_b16 v[74:75], v9 offset:3072
    s_add_u32 m0, s35, 6144
    s_add_u32 s44, s44, 7168
    v_mfma_f32_32x32x16_bf16 v[144:159], a[108:111], v[48:51], v[144:159]
    buffer_load_dwordx4 v8, s[40:43], s44 offen lds
    ds_read_b64_tr_b16 v[78:79], v26 offset:3072
    v_mfma_f32_32x32x16_bf16 v[160:175], a[104:107], v[52:55], v[160:175]
    ds_read_b128 v[44:47], v6 offset:15360
    s_waitcnt vmcnt(9)
    ds_read_b64_tr_b16 v[80:81], v56 offset:0
    s_add_u32 m0, s52, 47104
    s_add_u32 s28, s54, 47104
    v_mfma_f32_32x32x16_bf16 v[176:191], a[108:111], v[52:55], v[176:191]
    buffer_load_dwordx4 v3, s[8:11], s28 offen sc1 lds
    ds_read_b64_tr_b16 v[84:85], v57 offset:0
    s_waitcnt lgkmcnt(6)
    v_mfma_f32_32x32x16_bf16 v[128:143], a[112:115], v[32:35], v[128:143]
    ds_read_b128 v[48:51], v3 offset:16384
    s_add_u32 m0, s35, 2048
    s_add_u32 s44, s44, 7168
    v_mfma_f32_32x32x16_bf16 v[144:159], a[116:119], v[32:35], v[144:159]
    buffer_load_dwordx4 v8, s[40:43], s44 offen lds
    v_mfma_f32_32x32x16_bf16 v[160:175], a[112:115], v[36:39], v[160:175]
    ds_read_b128 v[52:55], v6 offset:16384
    s_waitcnt vmcnt(9)
    ds_read_b64_tr_b16 v[82:83], v56 offset:1024
    s_add_u32 m0, s35, 7168
    s_add_u32 s44, s44, 7168
    v_mfma_f32_32x32x16_bf16 v[176:191], a[116:119], v[36:39], v[176:191]
    buffer_load_dwordx4 v8, s[40:43], s44 offen lds
    ds_read_b64_tr_b16 v[86:87], v57 offset:1024
    s_waitcnt lgkmcnt(6)
    v_mfma_f32_32x32x16_bf16 v[128:143], a[120:123], v[40:43], v[128:143]
    ds_read_b128 v[32:35], v3 offset:17408
    s_waitcnt vmcnt(9)
    ds_read_b64_tr_b16 v[88:89], v9 offset:4096
    s_add_u32 m0, s52, 49152
    s_add_u32 s28, s54, 49152
    v_mfma_f32_32x32x16_bf16 v[144:159], a[124:127], v[40:43], v[144:159]
    buffer_load_dwordx4 v3, s[8:11], s28 offen sc1 lds
    ds_read_b64_tr_b16 v[92:93], v26 offset:4096
    v_mfma_f32_32x32x16_bf16 v[160:175], a[120:123], v[44:47], v[160:175]
    ds_read_b128 v[36:39], v6 offset:17408
    s_add_u32 m0, s35, 3072
    s_add_u32 s44, s44, 7168
    v_mfma_f32_32x32x16_bf16 v[176:191], a[124:127], v[44:47], v[176:191]
    buffer_load_dwordx4 v8, s[40:43], s44 offen lds
    s_waitcnt lgkmcnt(6)
    v_mfma_f32_32x32x16_bf16 v[128:143], a[128:131], v[48:51], v[128:143]
    ds_read_b128 v[40:43], v3 offset:18432
    s_waitcnt vmcnt(9)
    ds_read_b64_tr_b16 v[90:91], v9 offset:0
    s_add_u32 m0, s51, 0
    s_add_u32 s44, s44, 7168
    v_mfma_f32_32x32x16_bf16 v[144:159], a[132:135], v[48:51], v[144:159]
    buffer_load_dwordx4 v8, s[40:43], s44 offen lds
    ds_read_b64_tr_b16 v[94:95], v26 offset:0
    v_mfma_f32_32x32x16_bf16 v[160:175], a[128:131], v[52:55], v[160:175]
    ds_read_b128 v[44:47], v6 offset:18432
    s_waitcnt vmcnt(9)
    ds_read_b64_tr_b16 v[96:97], v9 offset:5120
    s_add_u32 m0, s52, 51200
    s_add_u32 s28, s54, 51200
    v_mfma_f32_32x32x16_bf16 v[176:191], a[132:135], v[52:55], v[176:191]
    buffer_load_dwordx4 v3, s[8:11], s28 offen sc1 lds
    ds_read_b64_tr_b16 v[100:101], v26 offset:5120
    s_waitcnt lgkmcnt(6)
    v_mfma_f32_32x32x16_bf16 v[128:143], a[136:139], v[32:35], v[128:143]
    ds_read_b128 v[48:51], v3 offset:19456
    s_add_u32 m0, s35, 4096
    s_add_u32 s44, s44, 7168
    v_mfma_f32_32x32x16_bf16 v[144:159], a[140:143], v[32:35], v[144:159]
    buffer_load_dwordx4 v8, s[40:43], s44 offen lds
    v_mfma_f32_32x32x16_bf16 v[160:175], a[136:139], v[36:39], v[160:175]
    ds_read_b128 v[52:55], v6 offset:19456
    s_waitcnt vmcnt(9)
    ds_read_b64_tr_b16 v[98:99], v9 offset:1024
    s_add_u32 m0, s51, 1024
    s_add_u32 s44, s44, 7168
    v_mfma_f32_32x32x16_bf16 v[176:191], a[140:143], v[36:39], v[176:191]
    buffer_load_dwordx4 v8, s[40:43], s44 offen lds
    ds_read_b64_tr_b16 v[102:103], v26 offset:1024
    s_waitcnt lgkmcnt(6)
    v_mfma_f32_32x32x16_bf16 v[128:143], a[144:147], v[40:43], v[128:143]
    ds_read_b128 v[32:35], v3 offset:20480
    s_waitcnt vmcnt(9)
    ds_read_b64_tr_b16 v[104:105], v9 offset:6144
    s_add_u32 m0, s52, 53248
    s_add_u32 s28, s54, 53248
    v_mfma_f32_32x32x16_bf16 v[144:159], a[148:151], v[40:43], v[144:159]
    buffer_load_dwordx4 v3, s[8:11], s28 offen sc1 lds
    ds_read_b64_tr_b16 v[108:109], v26 offset:6144
    v_mfma_f32_32x32x16_bf16 v[160:175], a[144:147], v[44:47], v[160:175]
    ds_read_b128 v[36:39], v6 offset:20480
    s_add_u32 m0, s35, 0
    s_add_u32 s44, s44, 7168
    v_mfma_f32_32x32x16_bf16 v[176:191], a[148:151], v[44:47], v[176:191]
    buffer_load_dwordx4 v8, s[40:43], s44 offen lds
    s_waitcnt lgkmcnt(6)
    v_mfma_f32_32x32x16_bf16 v[128:143], a[152:155], v[48:51], v[128:143]
    ds_read_b128 v[40:43], v3 offset:21504
    s_waitcnt vmcnt(9)
    ds_read_b64_tr_b16 v[106:107], v9 offset:2048
    s_add_u32 m0, s35, 5120
    s_add_u32 s44, s44, 7168
    v_mfma_f32_32x32x16_bf16 v[144:159], a[156:159], v[48:51], v[144:159]
    buffer_load_dwordx4 v8, s[40:43], s44 offen lds
    ds_read_b64_tr_b16 v[110:111], v26 offset:2048
    v_mfma_f32_32x32x16_bf16 v[160:175], a[152:155], v[52:55], v[160:175]
    ds_read_b128 v[44:47], v6 offset:21504
    s_waitcnt vmcnt(9)
    ds_read_b64_tr_b16 v[112:113], v9 offset:7168
    s_add_u32 m0, s52, 55296
    s_add_u32 s28, s54, 55296
    v_mfma_f32_32x32x16_bf16 v[176:191], a[156:159], v[52:55], v[176:191]
    buffer_load_dwordx4 v3, s[8:11], s28 offen sc1 lds
    ds_read_b64_tr_b16 v[116:117], v26 offset:7168
    s_waitcnt lgkmcnt(6)
    v_mfma_f32_32x32x16_bf16 v[128:143], a[160:163], v[32:35], v[128:143]
    ds_read_b128 v[48:51], v3 offset:22528
    s_add_u32 m0, s35, 1024
    s_add_u32 s44, s44, 7168
    v_mfma_f32_32x32x16_bf16 v[144:159], a[164:167], v[32:35], v[144:159]
    buffer_load_dwordx4 v8, s[40:43], s44 offen lds
    v_mfma_f32_32x32x16_bf16 v[160:175], a[160:163], v[36:39], v[160:175]
    ds_read_b128 v[52:55], v6 offset:22528
    s_waitcnt vmcnt(9)
    ds_read_b64_tr_b16 v[114:115], v9 offset:3072
    s_add_u32 m0, s35, 6144
    s_add_u32 s44, s22, 2
    s_and_b32 s44, s44, 3
    s_mul_i32 s44, s44, 100352
    s_add_u32 s44, s44, s34
    v_mfma_f32_32x32x16_bf16 v[176:191], a[164:167], v[36:39], v[176:191]
    buffer_load_dwordx4 v8, s[40:43], s44 offen lds
    ds_read_b64_tr_b16 v[118:119], v26 offset:3072
    s_waitcnt lgkmcnt(6)
    v_mfma_f32_32x32x16_bf16 v[128:143], a[168:171], v[40:43], v[128:143]
    ds_read_b128 v[32:35], v3 offset:23552
    s_waitcnt vmcnt(9)
    ds_read_b64_tr_b16 v[120:121], v56 offset:0
    s_add_u32 m0, s35, 2048
    s_add_u32 s44, s44, 7168
    v_mfma_f32_32x32x16_bf16 v[144:159], a[172:175], v[40:43], v[144:159]
    buffer_load_dwordx4 v8, s[40:43], s44 offen lds
    ds_read_b64_tr_b16 v[124:125], v57 offset:0
    v_mfma_f32_32x32x16_bf16 v[160:175], a[168:171], v[44:47], v[160:175]
    ds_read_b128 v[36:39], v6 offset:23552
    s_add_u32 m0, s51, 2048
    s_add_u32 s44, s44, 7168
    v_mfma_f32_32x32x16_bf16 v[176:191], a[172:175], v[44:47], v[176:191]
    buffer_load_dwordx4 v8, s[40:43], s44 offen lds
    s_waitcnt lgkmcnt(6)
    v_mfma_f32_32x32x16_bf16 v[128:143], a[176:179], v[48:51], v[128:143]
    ds_read_b128 v[40:43], v3 offset:24576
    s_waitcnt vmcnt(9)
    ds_read_b64_tr_b16 v[122:123], v9 offset:4096
    s_add_u32 m0, s35, 7168
    s_add_u32 s44, s44, 7168
    v_mfma_f32_32x32x16_bf16 v[144:159], a[180:183], v[48:51], v[144:159]
    buffer_load_dwordx4 v8, s[40:43], s44 offen lds
    ds_read_b64_tr_b16 v[126:127], v26 offset:4096
    v_mfma_f32_32x32x16_bf16 v[160:175], a[176:179], v[52:55], v[160:175]
    ds_read_b128 v[44:47], v6 offset:24576
    s_waitcnt vmcnt(9)
    ds_read_b64_tr_b16 a[0:1], v56 offset:1024
    s_add_u32 m0, s51, 3072
    s_add_u32 s44, s44, 7168
    v_mfma_f32_32x32x16_bf16 v[176:191], a[180:183], v[52:55], v[176:191]
    buffer_load_dwordx4 v8, s[40:43], s44 offen lds
    ds_read_b64_tr_b16 a[4:5], v57 offset:1024
    s_waitcnt lgkmcnt(6)
    v_mfma_f32_32x32x16_bf16 v[128:143], a[184:187], v[32:35], v[128:143]
    ds_read_b128 v[48:51], v3 offset:25600
    s_add_u32 m0, s35, 3072
    s_add_u32 s44, s44, 7168
    v_mfma_f32_32x32x16_bf16 v[144:159], a[188:191], v[32:35], v[144:159]
    buffer_load_dwordx4 v8, s[40:43], s44 offen lds
    v_mfma_f32_32x32x16_bf16 v[160:175], a[184:187], v[36:39], v[160:175]
    ds_read_b128 v[52:55], v6 offset:25600
    s_waitcnt vmcnt(9)
    ds_read_b64_tr_b16 a[2:3], v9 offset:0
    s_add_u32 m0, s51, 0
    s_add_u32 s44, s44, 7168
    v_mfma_f32_32x32x16_bf16 v[176:191], a[188:191], v[36:39], v[176:191]
    buffer_load_dwordx4 v8, s[40:43], s44 offen lds
    ds_read_b64_tr_b16 a[6:7], v26 offset:0
    s_waitcnt lgkmcnt(6)
    v_mfma_f32_32x32x16_bf16 v[128:143], a[192:195], v[40:43], v[128:143]
    ds_read_b128 v[32:35], v3 offset:26624
    s_waitcnt vmcnt(9)
    ds_read_b64_tr_b16 a[8:9], v9 offset:5120
    s_add_u32 m0, s35, 4096
    s_add_u32 s44, s44, 7168
    v_mfma_f32_32x32x16_bf16 v[144:159], a[196:199], v[40:43], v[144:159]
    buffer_load_dwordx4 v8, s[40:43], s44 offen lds
    ds_read_b64_tr_b16 a[12:13], v26 offset:5120
    v_mfma_f32_32x32x16_bf16 v[160:175], a[192:195], v[44:47], v[160:175]
    ds_read_b128 v[36:39], v6 offset:26624
    v_mfma_f32_32x32x16_bf16 v[176:191], a[196:199], v[44:47], v[176:191]
    s_waitcnt lgkmcnt(6)
    v_mfma_f32_32x32x16_bf16 v[128:143], a[200:203], v[48:51], v[128:143]
    ds_read_b128 v[40:43], v3 offset:27648
    s_waitcnt vmcnt(8)
    ds_read_b64_tr_b16 a[10:11], v9 offset:1024
    s_add_u32 m0, s51, 1024
    s_add_u32 s44, s44, 7168
    v_mfma_f32_32x32x16_bf16 v[144:159], a[204:207], v[48:51], v[144:159]
    buffer_load_dwordx4 v8, s[40:43], s44 offen lds
    ds_read_b64_tr_b16 a[14:15], v26 offset:1024
    v_mfma_f32_32x32x16_bf16 v[160:175], a[200:203], v[52:55], v[160:175]
    ds_read_b128 v[44:47], v6 offset:27648
    s_waitcnt vmcnt(8)
    ds_read_b64_tr_b16 a[16:17], v9 offset:6144
    v_mfma_f32_32x32x16_bf16 v[176:191], a[204:207], v[52:55], v[176:191]
    ds_read_b64_tr_b16 a[20:21], v26 offset:6144
    s_barrier
    s_waitcnt lgkmcnt(6)
    v_mfma_f32_32x32x16_bf16 v[128:143], a[208:211], v[32:35], v[128:143]
    ds_read_b128 v[48:51], v3 offset:32768
    s_waitcnt vmcnt(7)
    ds_read_b64_tr_b16 a[18:19], v9 offset:2048
    s_add_u32 m0, s35, 0
    s_add_u32 s44, s44, 7168
    v_mfma_f32_32x32x16_bf16 v[144:159], a[212:215], v[32:35], v[144:159]
    buffer_load_dwordx4 v8, s[40:43], s44 offen lds
    ds_read_b64_tr_b16 a[22:23], v26 offset:2048
    v_mfma_f32_32x32x16_bf16 v[160:175], a[208:211], v[36:39], v[160:175]
    ds_read_b128 v[52:55], v6 offset:32768
    s_waitcnt vmcnt(7)
    ds_read_b64_tr_b16 a[24:25], v56 offset:2048
    s_add_u32 m0, s35, 5120
    s_add_u32 s44, s44, 7168
    v_mfma_f32_32x32x16_bf16 v[176:191], a[212:215], v[36:39], v[176:191]
    buffer_load_dwordx4 v8, s[40:43], s44 offen lds
    ds_read_b64_tr_b16 a[28:29], v57 offset:2048
    s_waitcnt lgkmcnt(8)
    v_mfma_f32_32x32x16_bf16 v[128:143], a[216:219], v[40:43], v[128:143]
    ds_read_b128 v[32:35], v3 offset:33792
    s_waitcnt vmcnt(7)
    ds_read_b64_tr_b16 a[26:27], v9 offset:7168
    s_add_u32 m0, s35, 1024
    s_add_u32 s44, s44, 7168
    v_mfma_f32_32x32x16_bf16 v[144:159], a[220:223], v[40:43], v[144:159]
    buffer_load_dwordx4 v8, s[40:43], s44 offen lds
    ds_read_b64_tr_b16 a[30:31], v26 offset:7168
    v_mfma_f32_32x32x16_bf16 v[160:175], a[216:219], v[44:47], v[160:175]
    ds_read_b128 v[36:39], v6 offset:33792
    v_mfma_f32_32x32x16_bf16 v[176:191], a[220:223], v[44:47], v[176:191]
    s_waitcnt lgkmcnt(6)
    v_mfma_f32_32x32x16_bf16 v[192:207], a[32:35], v[48:51], v[192:207]
    ds_read_b128 v[40:43], v3 offset:34816
    s_add_u32 m0, s35, 2048
    s_add_u32 s44, s44, 7168
    v_mfma_f32_32x32x16_bf16 v[208:223], a[36:39], v[48:51], v[208:223]
    buffer_load_dwordx4 v8, s[40:43], s44 offen lds
    v_mfma_f32_32x32x16_bf16 v[224:239], a[32:35], v[52:55], v[224:239]
    ds_read_b128 v[44:47], v6 offset:34816
    v_mul_f32 v144, v128, v144
    v_mul_f32 v145, v129, v145
    s_add_u32 m0, s35, 6144
    s_add_u32 s44, s44, 7168
    v_mfma_f32_32x32x16_bf16 v[240:255], a[36:39], v[52:55], v[240:255]
    buffer_load_dwordx4 v8, s[40:43], s44 offen lds
    v_mul_f32 v146, v130, v146
    v_mul_f32 v147, v131, v147
    v_cvt_pk_bf16_f32 v128, v144, v145
    s_waitcnt lgkmcnt(2)
    v_mfma_f32_32x32x16_bf16 v[192:207], a[40:43], v[32:35], v[192:207]
    ds_read_b128 v[48:51], v3 offset:35840
    s_waitcnt vmcnt(9)
    ds_read_b64_tr_b16 a[32:33], v56 offset:3072
    v_mul_f32 v148, v132, v148
    v_mul_f32 v149, v133, v149
    v_cvt_pk_bf16_f32 v129, v146, v147
    s_add_u32 m0, s35, 7168
    s_add_u32 s44, s22, 3
    s_and_b32 s44, s44, 3
    s_mul_i32 s44, s44, 100352
    s_add_u32 s44, s44, s34
    v_mfma_f32_32x32x16_bf16 v[208:223], a[44:47], v[32:35], v[208:223]
    buffer_load_dwordx4 v8, s[40:43], s44 offen lds
    v_mul_f32 v150, v134, v150
    v_mul_f32 v151, v135, v151
    v_cvt_pk_bf16_f32 v130, v148, v149
    v_mfma_f32_32x32x16_bf16 v[224:239], a[40:43], v[36:39], v[224:239]
    ds_read_b128 v[52:55], v6 offset:35840
    ds_read_b64_tr_b16 a[36:37], v57 offset:3072
    v_mul_f32 v152, v136, v152
    v_mul_f32 v153, v137, v153
    v_cvt_pk_bf16_f32 v131, v150, v151
    s_add_u32 m0, s51, 2048
    s_add_u32 s44, s44, 7168
    v_mfma_f32_32x32x16_bf16 v[240:255], a[44:47], v[36:39], v[240:255]
    buffer_load_dwordx4 v8, s[40:43], s44 offen lds
    s_add_u32 s38, s36, 0
    buffer_store_dwordx4 v[128:131], v3, s[8:11], s38 offen offset:0 sc1
    s_waitcnt lgkmcnt(4)
    v_mfma_f32_32x32x16_bf16 v[192:207], a[48:51], v[40:43], v[192:207]
    ds_read_b128 v[32:35], v3 offset:36864
    s_waitcnt vmcnt(11)
    ds_read_b64_tr_b16 a[34:35], v9 offset:3072
    v_mul_f32 v154, v138, v154
    v_mul_f32 v155, v139, v155
    v_cvt_pk_bf16_f32 v132, v152, v153
    v_mfma_f32_32x32x16_bf16 v[208:223], a[52:55], v[40:43], v[208:223]
    v_mul_f32 v156, v140, v156
    v_mul_f32 v157, v141, v157
    v_cvt_pk_bf16_f32 v133, v154, v155
    v_mfma_f32_32x32x16_bf16 v[224:239], a[48:51], v[44:47], v[224:239]
    ds_read_b128 v[36:39], v6 offset:36864
    ds_read_b64_tr_b16 a[38:39], v26 offset:3072
    v_mul_f32 v158, v142, v158
    v_mul_f32 v159, v143, v159
    v_cvt_pk_bf16_f32 v134, v156, v157
    v_mfma_f32_32x32x16_bf16 v[240:255], a[52:55], v[44:47], v[240:255]
    v_mul_f32 v176, v160, v176
    v_mul_f32 v177, v161, v177
    v_cvt_pk_bf16_f32 v135, v158, v159
    s_waitcnt lgkmcnt(5)
    v_mfma_f32_32x32x16_bf16 v[192:207], a[56:59], v[48:51], v[192:207]
    ds_read_b128 v[40:43], v3 offset:37888
    s_waitcnt vmcnt(10)
    ds_read_b64_tr_b16 a[40:41], v56 offset:0
    buffer_store_dwordx4 v[132:135], v3, s[8:11], s38 offen offset:1024 sc1
    v_mfma_f32_32x32x16_bf16 v[208:223], a[60:63], v[48:51], v[208:223]
    v_mul_f32 v178, v162, v178
    v_mul_f32 v179, v163, v179
    v_cvt_pk_bf16_f32 v160, v176, v177
    v_mfma_f32_32x32x16_bf16 v[224:239], a[56:59], v[52:55], v[224:239]
    ds_read_b128 v[44:47], v6 offset:37888
    ds_read_b64_tr_b16 a[44:45], v57 offset:0
    v_mul_f32 v180, v164, v180
    v_mul_f32 v181, v165, v181
    v_cvt_pk_bf16_f32 v161, v178, v179
    v_mfma_f32_32x32x16_bf16 v[240:255], a[60:63], v[52:55], v[240:255]
    v_mul_f32 v182, v166, v182
    v_mul_f32 v183, v167, v183
    v_cvt_pk_bf16_f32 v162, v180, v181
    s_waitcnt lgkmcnt(5)
    v_mfma_f32_32x32x16_bf16 v[192:207], a[64:67], v[32:35], v[192:207]
    ds_read_b128 v[48:51], v3 offset:38912
    s_waitcnt vmcnt(10)
    ds_read_b64_tr_b16 a[42:43], v9 offset:4096
    v_mul_f32 v184, v168, v184
    v_mul_f32 v185, v169, v185
    v_cvt_pk_bf16_f32 v163, v182, v183
    s_add_u32 m0, s51, 3072
    s_add_u32 s44, s44, 7168
    v_mfma_f32_32x32x16_bf16 v[208:223], a[68:71], v[32:35], v[208:223]
    buffer_load_dwordx4 v8, s[40:43], s44 offen lds
    s_add_u32 s38, s36, 229376
    buffer_store_dwordx4 v[160:163], v3, s[8:11], s38 offen offset:0 sc1
    v_mfma_f32_32x32x16_bf16 v[224:239], a[64:67], v[36:39], v[224:239]
    ds_read_b128 v[52:55], v6 offset:38912
    ds_read_b64_tr_b16 a[46:47], v26 offset:4096
    v_mul_f32 v186, v170, v186
    v_mul_f32 v187, v171, v187
    v_cvt_pk_bf16_f32 v164, v184, v185
    v_mfma_f32_32x32x16_bf16 v[240:255], a[68:71], v[36:39], v[240:255]
    v_mul_f32 v188, v172, v188
    v_mul_f32 v189, v173, v189
    v_cvt_pk_bf16_f32 v165, v186, v187
    s_waitcnt lgkmcnt(5)
    v_mfma_f32_32x32x16_bf16 v[192:207], a[72:75], v[40:43], v[192:207]
    ds_read_b128 v[32:35], v3 offset:39936
    s_waitcnt vmcnt(11)
    ds_read_b64_tr_b16 a[48:49], v56 offset:1024
    v_mul_f32 v190, v174, v190
    v_mul_f32 v191, v175, v191
    v_cvt_pk_bf16_f32 v166, v188, v189
    s_add_u32 m0, s35, 3072
    s_add_u32 s44, s44, 7168
    v_mfma_f32_32x32x16_bf16 v[208:223], a[76:79], v[40:43], v[208:223]
    buffer_load_dwordx4 v8, s[40:43], s44 offen lds
    v_cvt_pk_bf16_f32 v167, v190, v191
    v_mfma_f32_32x32x16_bf16 v[224:239], a[72:75], v[44:47], v[224:239]
    ds_read_b128 v[36:39], v6 offset:39936
    ds_read_b64_tr_b16 a[52:53], v57 offset:1024
    buffer_store_dwordx4 v[164:167], v3, s[8:11], s38 offen offset:1024 sc1
    v_mfma_f32_32x32x16_bf16 v[240:255], a[76:79], v[44:47], v[240:255]
    s_waitcnt lgkmcnt(5)
    v_mfma_f32_32x32x16_bf16 v[192:207], a[80:83], v[48:51], v[192:207]
    ds_read_b128 v[40:43], v3 offset:40960
    s_waitcnt vmcnt(12)
    ds_read_b64_tr_b16 a[50:51], v9 offset:0
    s_add_u32 m0, s51, 0
    s_add_u32 s44, s44, 7168
    v_mfma_f32_32x32x16_bf16 v[208:223], a[84:87], v[48:51], v[208:223]
    buffer_load_dwordx4 v8, s[40:43], s44 offen lds
    ds_read_b64_tr_b16 a[54:55], v26 offset:0
    v_mfma_f32_32x32x16_bf16 v[224:239], a[80:83], v[52:55], v[224:239]
    ds_read_b128 v[44:47], v6 offset:40960
    s_waitcnt vmcnt(12)
    ds_read_b64_tr_b16 a[56:57], v9 offset:5120
    v_mfma_f32_32x32x16_bf16 v[240:255], a[84:87], v[52:55], v[240:255]
    ds_read_b64_tr_b16 a[60:61], v26 offset:5120
    s_waitcnt lgkmcnt(7)
    v_mfma_f32_32x32x16_bf16 v[192:207], a[88:91], v[32:35], v[192:207]
    ds_read_b128 v[48:51], v3 offset:41984
    s_waitcnt vmcnt(11)
    ds_read_b64_tr_b16 a[58:59], v9 offset:1024
    s_add_u32 m0, s35, 4096
    s_add_u32 s44, s44, 7168
    v_mfma_f32_32x32x16_bf16 v[208:223], a[92:95], v[32:35], v[208:223]
    buffer_load_dwordx4 v8, s[40:43], s44 offen lds
    ds_read_b64_tr_b16 a[62:63], v26 offset:1024
    v_mfma_f32_32x32x16_bf16 v[224:239], a[88:91], v[36:39], v[224:239]
    ds_read_b128 v[52:55], v6 offset:41984
    s_waitcnt vmcnt(11)
    ds_read_b64_tr_b16 a[64:65], v9 offset:2048
    v_mfma_f32_32x32x16_bf16 v[240:255], a[92:95], v[36:39], v[240:255]
    ds_read_b64_tr_b16 a[68:69], v26 offset:2048
    s_waitcnt lgkmcnt(8)
    v_mfma_f32_32x32x16_bf16 v[192:207], a[96:99], v[40:43], v[192:207]
    ds_read_b128 v[32:35], v3 offset:43008
    s_waitcnt vmcnt(10)
    ds_read_b64_tr_b16 a[66:67], v9 offset:6144
    s_add_u32 m0, s35, 0
    s_add_u32 s44, s44, 7168
    v_mfma_f32_32x32x16_bf16 v[208:223], a[100:103], v[40:43], v[208:223]
    buffer_load_dwordx4 v8, s[40:43], s44 offen lds
    ds_read_b64_tr_b16 a[70:71], v26 offset:6144
    v_mfma_f32_32x32x16_bf16 v[224:239], a[96:99], v[44:47], v[224:239]
    ds_read_b128 v[36:39], v6 offset:43008
    s_waitcnt vmcnt(10)
    ds_read_b64_tr_b16 a[72:73], v9 offset:7168
    s_add_u32 m0, s51, 1024
    s_add_u32 s44, s44, 7168
    v_mfma_f32_32x32x16_bf16 v[240:255], a[100:103], v[44:47], v[240:255]
    buffer_load_dwordx4 v8, s[40:43], s44 offen lds
    ds_read_b64_tr_b16 a[76:77], v26 offset:7168
    s_waitcnt lgkmcnt(8)
    v_mfma_f32_32x32x16_bf16 v[192:207], a[104:107], v[48:51], v[192:207]
    ds_read_b128 v[40:43], v3 offset:44032
    s_waitcnt vmcnt(10)
    ds_read_b64_tr_b16 a[74:75], v56 offset:2048
    s_add_u32 m0, s35, 1024
    s_add_u32 s44, s44, 7168
    v_mfma_f32_32x32x16_bf16 v[208:223], a[108:111], v[48:51], v[208:223]
    buffer_load_dwordx4 v8, s[40:43], s44 offen lds
    ds_read_b64_tr_b16 a[78:79], v57 offset:2048
    v_mfma_f32_32x32x16_bf16 v[224:239], a[104:107], v[52:55], v[224:239]
    ds_read_b128 v[44:47], v6 offset:44032
    s_add_u32 m0, s35, 5120
    s_add_u32 s44, s44, 7168
    v_mfma_f32_32x32x16_bf16 v[240:255], a[108:111], v[52:55], v[240:255]
    buffer_load_dwordx4 v8, s[40:43], s44 offen lds
    s_waitcnt lgkmcnt(6)
    v_mfma_f32_32x32x16_bf16 v[192:207], a[112:115], v[32:35], v[192:207]
    ds_read_b128 v[48:51], v3 offset:45056
    s_add_u32 m0, s35, 2048
    s_add_u32 s44, s44, 7168
    v_mfma_f32_32x32x16_bf16 v[208:223], a[116:119], v[32:35], v[208:223]
    buffer_load_dwordx4 v8, s[40:43], s44 offen lds
    v_mfma_f32_32x32x16_bf16 v[224:239], a[112:115], v[36:39], v[224:239]
    ds_read_b128 v[52:55], v6 offset:45056
    s_add_u32 m0, s35, 6144
    s_add_u32 s44, s44, 7168
    v_mfma_f32_32x32x16_bf16 v[240:255], a[116:119], v[36:39], v[240:255]
    buffer_load_dwordx4 v8, s[40:43], s44 offen lds
    s_waitcnt lgkmcnt(2)
    v_mfma_f32_32x32x16_bf16 v[192:207], a[120:123], v[40:43], v[192:207]
    ds_read_b128 v[32:35], v3 offset:46080
    s_add_u32 m0, s35, 7168
    s_add_u32 s44, s44, 7168
    v_mfma_f32_32x32x16_bf16 v[208:223], a[124:127], v[40:43], v[208:223]
    buffer_load_dwordx4 v8, s[40:43], s44 offen lds
    v_mfma_f32_32x32x16_bf16 v[224:239], a[120:123], v[44:47], v[224:239]
    ds_read_b128 v[36:39], v6 offset:46080
    s_add_u32 m0, s51, 2048
    s_add_u32 s44, s44, 7168
    v_mfma_f32_32x32x16_bf16 v[240:255], a[124:127], v[44:47], v[240:255]
    buffer_load_dwordx4 v8, s[40:43], s44 offen lds
    s_waitcnt lgkmcnt(2)
    v_mfma_f32_32x32x16_bf16 v[192:207], a[128:131], v[48:51], v[192:207]
    ds_read_b128 v[40:43], v3 offset:47104
    v_mfma_f32_32x32x16_bf16 v[208:223], a[132:135], v[48:51], v[208:223]
    v_mfma_f32_32x32x16_bf16 v[224:239], a[128:131], v[52:55], v[224:239]
    ds_read_b128 v[44:47], v6 offset:47104
    v_mfma_f32_32x32x16_bf16 v[240:255], a[132:135], v[52:55], v[240:255]
    s_waitcnt lgkmcnt(2)
    v_mfma_f32_32x32x16_bf16 v[192:207], a[136:139], v[32:35], v[192:207]
    ds_read_b128 v[48:51], v3 offset:48128
    s_waitcnt vmcnt(13)
    ds_read_b64_tr_b16 a[80:81], v56 offset:3072
    v_mfma_f32_32x32x16_bf16 v[208:223], a[140:143], v[32:35], v[208:223]
    ds_read_b64_tr_b16 a[84:85], v57 offset:3072
    v_mfma_f32_32x32x16_bf16 v[224:239], a[136:139], v[36:39], v[224:239]
    ds_read_b128 v[52:55], v6 offset:48128
    v_mfma_f32_32x32x16_bf16 v[240:255], a[140:143], v[36:39], v[240:255]
    s_waitcnt lgkmcnt(4)
    v_mfma_f32_32x32x16_bf16 v[192:207], a[144:147], v[40:43], v[192:207]
    ds_read_b128 v[32:35], v3 offset:49152
    s_waitcnt vmcnt(11)
    ds_read_b64_tr_b16 a[82:83], v9 offset:3072
    v_mfma_f32_32x32x16_bf16 v[208:223], a[148:151], v[40:43], v[208:223]
    ds_read_b64_tr_b16 a[86:87], v26 offset:3072
    v_mfma_f32_32x32x16_bf16 v[224:239], a[144:147], v[44:47], v[224:239]
    ds_read_b128 v[36:39], v6 offset:49152
    v_mfma_f32_32x32x16_bf16 v[240:255], a[148:151], v[44:47], v[240:255]
    s_waitcnt vmcnt(10)
    buffer_store_dword v2, off, s[8:11], s39 offset:256
    s_waitcnt lgkmcnt(4)
    v_mfma_f32_32x32x16_bf16 v[192:207], a[152:155], v[48:51], v[192:207]
    ds_read_b128 v[40:43], v3 offset:50176
    v_mfma_f32_32x32x16_bf16 v[208:223], a[156:159], v[48:51], v[208:223]
    v_mfma_f32_32x32x16_bf16 v[224:239], a[152:155], v[52:55], v[224:239]
    ds_read_b128 v[44:47], v6 offset:50176
    s_waitcnt vmcnt(10)
    ds_read_b64_tr_b16 a[88:89], v56 offset:0
    v_mfma_f32_32x32x16_bf16 v[240:255], a[156:159], v[52:55], v[240:255]
    ds_read_b64_tr_b16 a[92:93], v57 offset:0
    s_waitcnt lgkmcnt(4)
    v_mfma_f32_32x32x16_bf16 v[192:207], a[160:163], v[32:35], v[192:207]
    ds_read_b128 v[48:51], v3 offset:51200
    s_waitcnt vmcnt(9)
    ds_read_b64_tr_b16 a[90:91], v9 offset:4096
    v_mfma_f32_32x32x16_bf16 v[208:223], a[164:167], v[32:35], v[208:223]
    ds_read_b64_tr_b16 a[94:95], v26 offset:4096
    v_mfma_f32_32x32x16_bf16 v[224:239], a[160:163], v[36:39], v[224:239]
    ds_read_b128 v[52:55], v6 offset:51200
    s_waitcnt vmcnt(8)
    ds_read_b64_tr_b16 a[96:97], v9 offset:0
    v_mfma_f32_32x32x16_bf16 v[240:255], a[164:167], v[36:39], v[240:255]
    ds_read_b64_tr_b16 a[100:101], v26 offset:0
    s_waitcnt lgkmcnt(8)
    v_mfma_f32_32x32x16_bf16 v[192:207], a[168:171], v[40:43], v[192:207]
    ds_read_b128 v[32:35], v3 offset:52224
    s_waitcnt vmcnt(7)
    ds_read_b64_tr_b16 a[98:99], v56 offset:1024
    v_mfma_f32_32x32x16_bf16 v[208:223], a[172:175], v[40:43], v[208:223]
    ds_read_b64_tr_b16 a[102:103], v57 offset:1024
    v_mfma_f32_32x32x16_bf16 v[224:239], a[168:171], v[44:47], v[224:239]
    ds_read_b128 v[36:39], v6 offset:52224
    s_waitcnt vmcnt(6)
    ds_read_b64_tr_b16 a[104:105], v9 offset:1024
    v_mfma_f32_32x32x16_bf16 v[240:255], a[172:175], v[44:47], v[240:255]
    ds_read_b64_tr_b16 a[108:109], v26 offset:1024
    s_waitcnt lgkmcnt(8)
    v_mfma_f32_32x32x16_bf16 v[192:207], a[176:179], v[48:51], v[192:207]
    ds_read_b128 v[40:43], v3 offset:53248
    s_waitcnt vmcnt(5)
    ds_read_b64_tr_b16 a[106:107], v9 offset:5120
    v_mfma_f32_32x32x16_bf16 v[208:223], a[180:183], v[48:51], v[208:223]
    ds_read_b64_tr_b16 a[110:111], v26 offset:5120
    v_mfma_f32_32x32x16_bf16 v[224:239], a[176:179], v[52:55], v[224:239]
    ds_read_b128 v[44:47], v6 offset:53248
    s_waitcnt vmcnt(4)
    ds_read_b64_tr_b16 a[112:113], v9 offset:2048
    v_mfma_f32_32x32x16_bf16 v[240:255], a[180:183], v[52:55], v[240:255]
    ds_read_b64_tr_b16 a[116:117], v26 offset:2048
    buffer_load_dword v31, v0, s[8:11], s33 offen offset:256 sc1
    s_waitcnt lgkmcnt(8)
    v_mfma_f32_32x32x16_bf16 v[192:207], a[184:187], v[32:35], v[192:207]
    ds_read_b128 v[48:51], v3 offset:54272
    s_waitcnt vmcnt(4)
    ds_read_b64_tr_b16 a[114:115], v9 offset:6144
    v_mfma_f32_32x32x16_bf16 v[208:223], a[188:191], v[32:35], v[208:223]
    ds_read_b64_tr_b16 a[118:119], v26 offset:6144
    v_mfma_f32_32x32x16_bf16 v[224:239], a[184:187], v[36:39], v[224:239]
    ds_read_b128 v[52:55], v6 offset:54272
    s_waitcnt vmcnt(3)
    ds_read_b64_tr_b16 a[120:121], v9 offset:7168
    v_mfma_f32_32x32x16_bf16 v[240:255], a[188:191], v[36:39], v[240:255]
    ds_read_b64_tr_b16 a[124:125], v26 offset:7168
    s_waitcnt lgkmcnt(8)
    v_mfma_f32_32x32x16_bf16 v[192:207], a[192:195], v[40:43], v[192:207]
    ds_read_b128 v[32:35], v3 offset:55296
    s_waitcnt vmcnt(2)
    ds_read_b64_tr_b16 a[122:123], v56 offset:2048
    v_mfma_f32_32x32x16_bf16 v[208:223], a[196:199], v[40:43], v[208:223]
    ds_read_b64_tr_b16 a[126:127], v57 offset:2048
    v_mfma_f32_32x32x16_bf16 v[224:239], a[192:195], v[44:47], v[224:239]
    ds_read_b128 v[36:39], v6 offset:55296
    v_mfma_f32_32x32x16_bf16 v[240:255], a[196:199], v[44:47], v[240:255]
    s_waitcnt vmcnt(0)
    v_cmp_eq_u32 vcc, 0, v31
    s_mov_b32 s50, 262144
    s_cbranch_vccnz L_se_poll_20
L_se_done_21:
    s_waitcnt lgkmcnt(6)
    v_mfma_f32_32x32x16_bf16 v[192:207], a[200:203], v[48:51], v[192:207]
    ds_read_b128 v[40:43], v3 offset:56320
    s_add_u32 s45, s22, 0
    s_and_b32 s45, s45, 3
    s_mul_i32 s45, s45, 7168
    s_add_u32 s45, s45, s37
    v_mfma_f32_32x32x16_bf16 v[208:223], a[204:207], v[48:51], v[208:223]
    buffer_load_dwordx4 a[128:131], v3, s[8:11], s45 offen offset:0 sc1
    v_mfma_f32_32x32x16_bf16 v[224:239], a[200:203], v[52:55], v[224:239]
    ds_read_b128 v[44:47], v6 offset:56320
    v_mfma_f32_32x32x16_bf16 v[240:255], a[204:207], v[52:55], v[240:255]
    buffer_load_dwordx4 a[132:135], v3, s[8:11], s45 offen offset:1024 sc1
    s_waitcnt lgkmcnt(2)
    v_mfma_f32_32x32x16_bf16 v[192:207], a[208:211], v[32:35], v[192:207]
    v_mfma_f32_32x32x16_bf16 v[208:223], a[212:215], v[32:35], v[208:223]
    buffer_load_dwordx4 a[136:139], v3, s[8:11], s45 offen offset:2048 sc1
    v_mfma_f32_32x32x16_bf16 v[224:239], a[208:211], v[36:39], v[224:239]
    v_mfma_f32_32x32x16_bf16 v[240:255], a[212:215], v[36:39], v[240:255]
    buffer_load_dwordx4 a[140:143], v3, s[8:11], s45 offen offset:3072 sc1
    s_waitcnt lgkmcnt(0)
    v_mfma_f32_32x32x16_bf16 v[192:207], a[216:219], v[40:43], v[192:207]
    s_add_u32 s45, s45, 4096
    v_mfma_f32_32x32x16_bf16 v[208:223], a[220:223], v[40:43], v[208:223]
    buffer_load_dwordx4 a[144:147], v3, s[8:11], s45 offen offset:0 sc1
    v_mfma_f32_32x32x16_bf16 v[224:239], a[216:219], v[44:47], v[224:239]
    v_mfma_f32_32x32x16_bf16 v[240:255], a[220:223], v[44:47], v[240:255]
    buffer_load_dwordx4 a[148:151], v3, s[8:11], s45 offen offset:1024 sc1
    buffer_load_dwordx4 a[152:155], v3, s[8:11], s45 offen offset:2048 sc1
    s_nop 6
    v_mul_f32 v208, v192, v208
    v_mul_f32 v209, v193, v209
    v_mul_f32 v210, v194, v210
    v_mul_f32 v211, v195, v211
    v_cvt_pk_bf16_f32 v192, v208, v209
    s_add_u32 s45, s22, 1
    s_and_b32 s45, s45, 3
    s_mul_i32 s45, s45, 7168
    s_add_u32 s45, s45, s37
    buffer_load_dwordx4 a[156:159], v3, s[8:11], s45 offen offset:0 sc1
    v_mul_f32 v212, v196, v212
    v_mul_f32 v213, v197, v213
    v_cvt_pk_bf16_f32 v193, v210, v211
    v_mul_f32 v214, v198, v214
    v_mul_f32 v215, v199, v215
    v_cvt_pk_bf16_f32 v194, v212, v213
    v_mul_f32 v216, v200, v216
    v_mul_f32 v217, v201, v217
    v_cvt_pk_bf16_f32 v195, v214, v215
    s_lshl_b32 s38, s25, 15
    s_add_u32 s38, s38, s55
    buffer_store_dwordx4 v[192:195], v11, s[8:11], s38 offen offset:0
    v_mul_f32 v218, v202, v218
    v_mul_f32 v219, v203, v219
    v_cvt_pk_bf16_f32 v196, v216, v217
    v_mul_f32 v220, v204, v220
    v_mul_f32 v221, v205, v221
    v_cvt_pk_bf16_f32 v197, v218, v219
    v_mul_f32 v222, v206, v222
    v_mul_f32 v223, v207, v223
    v_cvt_pk_bf16_f32 v198, v220, v221
    v_mul_f32 v240, v224, v240
    v_mul_f32 v241, v225, v241
    v_cvt_pk_bf16_f32 v199, v222, v223
    s_add_u32 s38, s38, 16384
    buffer_store_dwordx4 v[196:199], v11, s[8:11], s38 offen offset:0
    v_mul_f32 v242, v226, v242
    v_mul_f32 v243, v227, v243
    v_cvt_pk_bf16_f32 v224, v240, v241
    v_mul_f32 v244, v228, v244
    v_mul_f32 v245, v229, v245
    v_cvt_pk_bf16_f32 v225, v242, v243
    v_mul_f32 v246, v230, v246
    v_mul_f32 v247, v231, v247
    v_cvt_pk_bf16_f32 v226, v244, v245
    v_mul_f32 v248, v232, v248
    v_mul_f32 v249, v233, v249
    v_cvt_pk_bf16_f32 v227, v246, v247
    s_lshl_b32 s38, s25, 11
    s_add_u32 s38, s38, s56
    buffer_store_dwordx4 v[224:227], v3, s[8:11], s38 offen offset:0
    v_mul_f32 v250, v234, v250
    v_mul_f32 v251, v235, v251
    v_cvt_pk_bf16_f32 v228, v248, v249
    v_mul_f32 v252, v236, v252
    v_mul_f32 v253, v237, v253
    v_cvt_pk_bf16_f32 v229, v250, v251
    v_mul_f32 v254, v238, v254
    v_mul_f32 v255, v239, v255
    v_cvt_pk_bf16_f32 v230, v252, v253
    v_cvt_pk_bf16_f32 v231, v254, v255
    buffer_store_dwordx4 v[228:231], v3, s[8:11], s38 offen offset:1024
    s_waitcnt vmcnt(11)
    v_mfma_f32_32x32x16_bf16 v[128:143], a[224:227], a[128:131], 0
    buffer_load_dwordx4 a[160:163], v3, s[8:11], s45 offen offset:1024 sc1
    v_mfma_f32_32x32x16_bf16 v[144:159], a[228:231], a[128:131], 0
    v_and_b32 v6, 31, v1
    v_lshrrev_b32 v7, 5, v1
    v_and_b32 v27, 7, v1
    v_xor_b32 v7, v7, v27
    s_waitcnt vmcnt(11)
    v_mfma_f32_32x32x16_bf16 v[128:143], a[232:235], a[132:135], v[128:143]
    buffer_load_dwordx4 a[164:167], v3, s[8:11], s45 offen offset:2048 sc1
    v_mfma_f32_32x32x16_bf16 v[144:159], a[236:239], a[132:135], v[144:159]
    s_lshl_b32 s26, s20, 13
    v_lshlrev_b32 v7, 4, v7
    v_lshl_add_u32 v7, v6, 8, v7
    v_add_u32 v12, s26, v7
    s_waitcnt vmcnt(11)
    v_mfma_f32_32x32x16_bf16 v[128:143], a[240:243], a[136:139], v[128:143]
    buffer_load_dwordx4 a[168:171], v3, s[8:11], s45 offen offset:3072 sc1
    v_mfma_f32_32x32x16_bf16 v[144:159], a[244:247], a[136:139], v[144:159]
    v_xor_b32 v13, 32, v12
    v_xor_b32 v14, 64, v12
    v_xor_b32 v15, 96, v12
    v_xor_b32 v16, 128, v12
    s_waitcnt vmcnt(11)
    v_mfma_f32_32x32x16_bf16 v[128:143], a[248:251], a[140:143], v[128:143]
    s_add_u32 s45, s45, 4096
    buffer_load_dwordx4 a[172:175], v3, s[8:11], s45 offen offset:0 sc1
    v_mfma_f32_32x32x16_bf16 v[144:159], a[252:255], a[140:143], v[144:159]
    v_xor_b32 v17, 160, v12
    v_xor_b32 v18, 192, v12
    v_xor_b32 v19, 224, v12
    s_waitcnt vmcnt(11)
    v_mfma_f32_32x32x16_bf16 v[128:143], v[64:67], a[144:147], v[128:143]
    buffer_load_dwordx4 a[176:179], v3, s[8:11], s45 offen offset:1024 sc1
    v_mfma_f32_32x32x16_bf16 v[144:159], v[68:71], a[144:147], v[144:159]
    v_lshrrev_b32 v6, 3, v1
    s_and_b32 s26, s20, 1
    s_lshl_b32 s26, s26, 2
    v_xor_b32 v7, v27, v4
    v_xor_b32 v7, s26, v7
    s_waitcnt vmcnt(11)
    v_mfma_f32_32x32x16_bf16 v[128:143], v[72:75], a[148:151], v[128:143]
    buffer_load_dwordx4 a[180:183], v3, s[8:11], s45 offen offset:2048 sc1
    v_mfma_f32_32x32x16_bf16 v[144:159], v[76:79], a[148:151], v[144:159]
    v_lshlrev_b32 v7, 1, v7
    v_xor_b32 v7, v7, v6
    s_lshl_b32 s26, s20, 11
    v_lshlrev_b32 v7, 4, v7
    s_waitcnt vmcnt(11)
    v_mfma_f32_32x32x16_bf16 v[128:143], v[80:83], a[152:155], v[128:143]
    s_add_u32 s45, s22, 2
    s_and_b32 s45, s45, 3
    s_mul_i32 s45, s45, 7168
    s_add_u32 s45, s45, s37
    buffer_load_dwordx4 a[184:187], v3, s[8:11], s45 offen offset:0 sc1
    v_mfma_f32_32x32x16_bf16 v[144:159], v[84:87], a[152:155], v[144:159]
    v_lshl_add_u32 v7, v6, 8, v7
    v_add_u32 v20, s26, v7
    v_xor_b32 v21, 16, v20
    s_waitcnt vmcnt(11)
    v_mfma_f32_32x32x16_bf16 v[128:143], v[88:91], a[156:159], v[128:143]
    buffer_load_dwordx4 a[188:191], v3, s[8:11], s45 offen offset:1024 sc1
    v_mfma_f32_32x32x16_bf16 v[144:159], v[92:95], a[156:159], v[144:159]
    s_lshl_b32 s26, s20, 10
    s_add_u32 s26, s26, 114688
    v_add_u32 v24, s26, v3
    s_lshl_b32 s26, s20, 5
    v_lshl_add_u32 v28, v6, 2, s26
    s_waitcnt vmcnt(8)
    buffer_store_dword v2, off, s[8:11], s39 offset:512
    s_waitcnt vmcnt(8)
    v_mfma_f32_32x32x16_bf16 v[128:143], v[96:99], a[160:163], v[128:143]
    buffer_load_dwordx4 a[192:195], v3, s[8:11], s45 offen offset:2048 sc1
    v_mfma_f32_32x32x16_bf16 v[144:159], v[100:103], a[160:163], v[144:159]
    buffer_load_dword v32, v30, s[8:11], s61 offen offset:0 sc1
    buffer_load_dword v33, v30, s[8:11], s61 offen offset:256 sc1
    s_waitcnt vmcnt(10)
    v_mfma_f32_32x32x16_bf16 v[128:143], v[104:107], a[164:167], v[128:143]
    buffer_load_dwordx4 a[196:199], v3, s[8:11], s45 offen offset:3072 sc1
    v_mfma_f32_32x32x16_bf16 v[144:159], v[108:111], a[164:167], v[144:159]
    buffer_load_dword v34, v30, s[8:11], s61 offen offset:512 sc1
    buffer_load_dword v35, v30, s[8:11], s61 offen offset:768 sc1
    s_waitcnt vmcnt(12)
    v_mfma_f32_32x32x16_bf16 v[128:143], v[112:115], a[168:171], v[128:143]
    s_add_u32 s45, s45, 4096
    buffer_load_dwordx4 a[200:203], v3, s[8:11], s45 offen offset:0 sc1
    v_mfma_f32_32x32x16_bf16 v[144:159], v[116:119], a[168:171], v[144:159]
    buffer_load_dword v36, v30, s[8:11], s61 offen offset:1024 sc1
    buffer_load_dword v37, v30, s[8:11], s61 offen offset:1280 sc1
    s_waitcnt vmcnt(14)
    v_mfma_f32_32x32x16_bf16 v[128:143], v[120:123], a[172:175], v[128:143]
    buffer_load_dwordx4 a[204:207], v3, s[8:11], s45 offen offset:1024 sc1
    v_mfma_f32_32x32x16_bf16 v[144:159], v[124:127], a[172:175], v[144:159]
    buffer_load_dword v38, v30, s[8:11], s61 offen offset:1536 sc1
    s_waitcnt vmcnt(15)
    v_mfma_f32_32x32x16_bf16 v[128:143], a[0:3], a[176:179], v[128:143]
    buffer_load_dwordx4 a[208:211], v3, s[8:11], s45 offen offset:2048 sc1
    v_mfma_f32_32x32x16_bf16 v[144:159], a[4:7], a[176:179], v[144:159]
    buffer_load_dword v31, v0, s[8:11], s33 offen offset:512 sc1
    s_waitcnt vmcnt(16)
    v_mfma_f32_32x32x16_bf16 v[128:143], a[8:11], a[180:183], v[128:143]
    s_add_u32 s45, s22, 3
    s_and_b32 s45, s45, 3
    s_mul_i32 s45, s45, 7168
    s_add_u32 s45, s45, s37
    buffer_load_dwordx4 a[212:215], v3, s[8:11], s45 offen offset:0 sc1
    v_mfma_f32_32x32x16_bf16 v[144:159], a[12:15], a[180:183], v[144:159]
    s_waitcnt vmcnt(16)
    v_mfma_f32_32x32x16_bf16 v[128:143], a[16:19], a[184:187], v[128:143]
    buffer_load_dwordx4 a[216:219], v3, s[8:11], s45 offen offset:1024 sc1
    v_mfma_f32_32x32x16_bf16 v[144:159], a[20:23], a[184:187], v[144:159]
    s_waitcnt vmcnt(16)
    v_mfma_f32_32x32x16_bf16 v[128:143], a[24:27], a[188:191], v[128:143]
    buffer_load_dwordx4 a[220:223], v3, s[8:11], s45 offen offset:2048 sc1
    v_mfma_f32_32x32x16_bf16 v[144:159], a[28:31], a[188:191], v[144:159]
    s_waitcnt vmcnt(15)
    v_mfma_f32_32x32x16_bf16 v[128:143], a[32:35], a[192:195], v[128:143]
    buffer_load_dwordx4 a[128:131], v3, s[8:11], s45 offen offset:3072 sc1
    v_mfma_f32_32x32x16_bf16 v[144:159], a[36:39], a[192:195], v[144:159]
    s_waitcnt vmcnt(4)
    v_cmp_eq_u32 vcc, 0, v31
    s_mov_b32 s50, 262144
    s_cbranch_vccnz L_se_poll_22
L_se_done_23:
    v_mfma_f32_32x32x16_bf16 v[128:143], a[40:43], a[196:199], v[128:143]
    s_add_u32 s45, s45, 4096
    buffer_load_dwordx4 a[132:135], v3, s[8:11], s45 offen offset:0 sc1
    v_mfma_f32_32x32x16_bf16 v[144:159], a[44:47], a[196:199], v[144:159]
    v_mfma_f32_32x32x16_bf16 v[128:143], a[48:51], a[200:203], v[128:143]
    buffer_load_dwordx4 a[136:139], v3, s[8:11], s45 offen offset:1024 sc1
    v_mfma_f32_32x32x16_bf16 v[144:159], a[52:55], a[200:203], v[144:159]
    v_mfma_f32_32x32x16_bf16 v[128:143], a[56:59], a[204:207], v[128:143]
    buffer_load_dwordx4 a[140:143], v3, s[8:11], s45 offen offset:2048 sc1
    v_mfma_f32_32x32x16_bf16 v[144:159], a[60:63], a[204:207], v[144:159]
    v_mfma_f32_32x32x16_bf16 v[128:143], a[64:67], a[208:211], v[128:143]
    s_cmp_eq_u32 s23, 0
    s_movk_i32 s58, 1024
    s_cselect_b32 s57, 0x4000, s58
    s_cselect_b32 s59, s55, s56
    s_cselect_b64 vcc, -1, 0
    s_mul_i32 s58, s20, 28
    s_mul_i32 s58, s58, s57
    s_add_u32 s59, s59, s58
    v_cndmask_b32 v25, v3, v11, vcc
    s_mul_i32 s58, s57, 7
    s_add_u32 s45, s22, 0
    s_and_b32 s45, s45, 3
    s_mul_i32 s45, s45, s58
    s_add_u32 s45, s45, s59
    buffer_load_dwordx4 a[144:147], v25, s[8:11], s45 offen sc1
    v_mfma_f32_32x32x16_bf16 v[144:159], a[68:71], a[208:211], v[144:159]
    s_waitcnt vmcnt(7)
    v_mfma_f32_32x32x16_bf16 v[128:143], a[72:75], a[212:215], v[128:143]
    s_add_u32 s45, s45, s57
    buffer_load_dwordx4 a[148:151], v25, s[8:11], s45 offen sc1
    v_mfma_f32_32x32x16_bf16 v[144:159], a[76:79], a[212:215], v[144:159]
    s_waitcnt vmcnt(7)
    v_mfma_f32_32x32x16_bf16 v[128:143], a[80:83], a[216:219], v[128:143]
    s_add_u32 s45, s45, s57
    buffer_load_dwordx4 a[152:155], v25, s[8:11], s45 offen sc1
    v_mfma_f32_32x32x16_bf16 v[144:159], a[84:87], a[216:219], v[144:159]
    v_add_f32 v32, v32, v33
    v_add_f32 v34, v34, v35
    v_add_f32 v36, v36, v37
    v_add_f32 v32, v32, v38
    s_waitcnt vmcnt(7)
    v_mfma_f32_32x32x16_bf16 v[128:143], a[88:91], a[220:223], v[128:143]
    s_add_u32 s45, s45, s57
    buffer_load_dwordx4 a[156:159], v25, s[8:11], s45 offen sc1
    v_mfma_f32_32x32x16_bf16 v[144:159], a[92:95], a[220:223], v[144:159]
    v_add_f32 v34, v34, v36
    v_mov_b32 v33, 0x3727c5ac
    v_add_f32 v32, v32, v34
    v_fmac_f32 v33, 0x3b124925, v32
    s_waitcnt vmcnt(7)
    v_mfma_f32_32x32x16_bf16 v[128:143], a[96:99], a[128:131], v[128:143]
    s_add_u32 s45, s45, s57
    buffer_load_dwordx4 a[160:163], v25, s[8:11], s45 offen sc1
    v_mfma_f32_32x32x16_bf16 v[144:159], a[100:103], a[128:131], v[144:159]
    v_rcp_f32 v32, v33
    v_add_u32 v29, 128, v28
    s_waitcnt vmcnt(7)
    v_mfma_f32_32x32x16_bf16 v[128:143], a[104:107], a[132:135], v[128:143]
    s_add_u32 s45, s45, s57
    buffer_load_dwordx4 a[164:167], v25, s[8:11], s45 offen sc1
    v_mfma_f32_32x32x16_bf16 v[144:159], a[108:111], a[132:135], v[144:159]
    ds_bpermute_b32 v22, v28, v32
    ds_bpermute_b32 v23, v29, v32
    s_waitcnt vmcnt(7)
    v_mfma_f32_32x32x16_bf16 v[128:143], a[112:115], a[136:139], v[128:143]
    s_add_u32 s45, s45, s57
    buffer_load_dwordx4 a[168:171], v25, s[8:11], s45 offen sc1
    v_mfma_f32_32x32x16_bf16 v[144:159], a[116:119], a[136:139], v[144:159]
    s_waitcnt vmcnt(7)
    v_mfma_f32_32x32x16_bf16 v[128:143], a[120:123], a[140:143], v[128:143]
    s_add_u32 s45, s22, 1
    s_and_b32 s45, s45, 3
    s_mul_i32 s45, s45, s58
    s_add_u32 s45, s45, s59
    buffer_load_dwordx4 a[172:175], v25, s[8:11], s45 offen sc1
    v_mfma_f32_32x32x16_bf16 v[144:159], a[124:127], a[140:143], v[144:159]
    s_waitcnt vmcnt(7)
    v_mfma_f32_32x32x16_bf16 v[160:175], a[224:227], a[144:147], 0
    s_add_u32 s45, s45, s57
    buffer_load_dwordx4 a[176:179], v25, s[8:11], s45 offen sc1
    v_mfma_f32_32x32x16_bf16 v[176:191], a[228:231], a[144:147], 0
    s_waitcnt vmcnt(7)
    v_mfma_f32_32x32x16_bf16 v[160:175], a[232:235], a[148:151], v[160:175]
    s_add_u32 s45, s45, s57
    buffer_load_dwordx4 a[180:183], v25, s[8:11], s45 offen sc1
    v_mfma_f32_32x32x16_bf16 v[176:191], a[236:239], a[148:151], v[176:191]
    ds_write_b128 v12, v[128:131] offset:0
    s_waitcnt vmcnt(7)
    v_mfma_f32_32x32x16_bf16 v[160:175], a[240:243], a[152:155], v[160:175]
    s_add_u32 s45, s45, s57
    buffer_load_dwordx4 a[184:187], v25, s[8:11], s45 offen sc1
    v_mfma_f32_32x32x16_bf16 v[176:191], a[244:247], a[152:155], v[176:191]
    ds_write_b128 v13, v[132:135] offset:0
    s_waitcnt vmcnt(7)
    v_mfma_f32_32x32x16_bf16 v[160:175], a[248:251], a[156:159], v[160:175]
    s_add_u32 s45, s45, s57
    buffer_load_dwordx4 a[188:191], v25, s[8:11], s45 offen sc1
    v_mfma_f32_32x32x16_bf16 v[176:191], a[252:255], a[156:159], v[176:191]
    ds_write_b128 v14, v[136:139] offset:0
    s_waitcnt vmcnt(7)
    v_mfma_f32_32x32x16_bf16 v[160:175], v[64:67], a[160:163], v[160:175]
    s_add_u32 s45, s45, s57
    buffer_load_dwordx4 a[192:195], v25, s[8:11], s45 offen sc1
    v_mfma_f32_32x32x16_bf16 v[176:191], v[68:71], a[160:163], v[176:191]
    ds_write_b128 v15, v[140:143] offset:0
    s_waitcnt vmcnt(7)
    v_mfma_f32_32x32x16_bf16 v[160:175], v[72:75], a[164:167], v[160:175]
    s_add_u32 s45, s45, s57
    buffer_load_dwordx4 a[196:199], v25, s[8:11], s45 offen sc1
    v_mfma_f32_32x32x16_bf16 v[176:191], v[76:79], a[164:167], v[176:191]
    ds_write_b128 v16, v[144:147] offset:0
    s_waitcnt vmcnt(7)
    v_mfma_f32_32x32x16_bf16 v[160:175], v[80:83], a[168:171], v[160:175]
    s_add_u32 s45, s22, 2
    s_and_b32 s45, s45, 3
    s_mul_i32 s45, s45, s58
    s_add_u32 s45, s45, s59
    buffer_load_dwordx4 a[200:203], v25, s[8:11], s45 offen sc1
    v_mfma_f32_32x32x16_bf16 v[176:191], v[84:87], a[168:171], v[176:191]
    ds_write_b128 v17, v[148:151] offset:0
    s_waitcnt vmcnt(7)
    v_mfma_f32_32x32x16_bf16 v[160:175], v[88:91], a[172:175], v[160:175]
    s_add_u32 s45, s45, s57
    buffer_load_dwordx4 a[204:207], v25, s[8:11], s45 offen sc1
    v_mfma_f32_32x32x16_bf16 v[176:191], v[92:95], a[172:175], v[176:191]
    ds_write_b128 v18, v[152:155] offset:0
    s_waitcnt vmcnt(7)
    v_mfma_f32_32x32x16_bf16 v[160:175], v[96:99], a[176:179], v[160:175]
    s_add_u32 s45, s45, s57
    buffer_load_dwordx4 a[208:211], v25, s[8:11], s45 offen sc1
    v_mfma_f32_32x32x16_bf16 v[176:191], v[100:103], a[176:179], v[176:191]
    ds_write_b128 v19, v[156:159] offset:0
    s_waitcnt vmcnt(7)
    v_mfma_f32_32x32x16_bf16 v[160:175], v[104:107], a[180:183], v[160:175]
    s_add_u32 s45, s45, s57
    buffer_load_dwordx4 a[212:215], v25, s[8:11], s45 offen sc1
    v_mfma_f32_32x32x16_bf16 v[176:191], v[108:111], a[180:183], v[176:191]
    ds_read_b128 v[224:227], v24 offset:0
    s_waitcnt vmcnt(7)
    v_mfma_f32_32x32x16_bf16 v[160:175], v[112:115], a[184:187], v[160:175]
    s_add_u32 s45, s45, s57
    buffer_load_dwordx4 a[216:219], v25, s[8:11], s45 offen sc1
    v_mfma_f32_32x32x16_bf16 v[176:191], v[116:119], a[184:187], v[176:191]
    s_waitcnt lgkmcnt(0)
    s_barrier
    ds_read_b128 v[192:195], v20 offset:0
    ds_read_b128 v[196:199], v21 offset:0
    s_waitcnt vmcnt(7)
    v_mfma_f32_32x32x16_bf16 v[160:175], v[120:123], a[188:191], v[160:175]
    s_add_u32 s45, s45, s57
    buffer_load_dwordx4 a[220:223], v25, s[8:11], s45 offen sc1
    v_mfma_f32_32x32x16_bf16 v[176:191], v[124:127], a[188:191], v[176:191]
    ds_read_b128 v[200:203], v20 offset:8192
    ds_read_b128 v[204:207], v21 offset:8192
    s_waitcnt vmcnt(7)
    v_mfma_f32_32x32x16_bf16 v[160:175], a[0:3], a[192:195], v[160:175]
    s_add_u32 s45, s45, s57
    buffer_load_dwordx4 a[128:131], v25, s[8:11], s45 offen sc1
    v_mfma_f32_32x32x16_bf16 v[176:191], a[4:7], a[192:195], v[176:191]
    ds_read_b128 v[208:211], v20 offset:16384
    ds_read_b128 v[212:215], v21 offset:16384
    s_waitcnt vmcnt(7)
    v_mfma_f32_32x32x16_bf16 v[160:175], a[8:11], a[196:199], v[160:175]
    s_add_u32 s45, s22, 3
    s_and_b32 s45, s45, 3
    s_mul_i32 s45, s45, s58
    s_add_u32 s45, s45, s59
    buffer_load_dwordx4 a[132:135], v25, s[8:11], s45 offen sc1
    v_mfma_f32_32x32x16_bf16 v[176:191], a[12:15], a[196:199], v[176:191]
    ds_read_b128 v[216:219], v20 offset:24576
    ds_read_b128 v[220:223], v21 offset:24576
    s_waitcnt vmcnt(7)
    v_mfma_f32_32x32x16_bf16 v[160:175], a[16:19], a[200:203], v[160:175]
    s_add_u32 s45, s45, s57
    buffer_load_dwordx4 a[136:139], v25, s[8:11], s45 offen sc1
    v_mfma_f32_32x32x16_bf16 v[176:191], a[20:23], a[200:203], v[176:191]
    v_lshlrev_b32 v228, 16, v224
    v_and_b32 v229, 0xffff0000, v224
    v_lshlrev_b32 v230, 16, v225
    v_and_b32 v231, 0xffff0000, v225
    s_waitcnt vmcnt(7)
    v_mfma_f32_32x32x16_bf16 v[160:175], a[24:27], a[204:207], v[160:175]
    s_add_u32 s45, s45, s57
    buffer_load_dwordx4 a[140:143], v25, s[8:11], s45 offen sc1
    v_mfma_f32_32x32x16_bf16 v[176:191], a[28:31], a[204:207], v[176:191]
    v_lshlrev_b32 v232, 16, v226
    v_and_b32 v233, 0xffff0000, v226
    v_lshlrev_b32 v234, 16, v227
    v_and_b32 v235, 0xffff0000, v227
    s_add_u32 s26, s39, 16384
    buffer_store_dword v2, off, s[8:11], s26
    s_waitcnt vmcnt(8)
    v_mfma_f32_32x32x16_bf16 v[160:175], a[32:35], a[208:211], v[160:175]
    s_add_u32 s45, s45, s57
    buffer_load_dwordx4 a[144:147], v25, s[8:11], s45 offen sc1
    v_mfma_f32_32x32x16_bf16 v[176:191], a[36:39], a[208:211], v[176:191]
    s_waitcnt lgkmcnt(4)
    v_add_f32 v192, v192, v200
    v_add_f32 v193, v193, v201
    v_add_f32 v194, v194, v202
    v_add_f32 v195, v195, v203
    s_waitcnt vmcnt(8)
    v_mfma_f32_32x32x16_bf16 v[160:175], a[40:43], a[212:215], v[160:175]
    s_add_u32 s45, s45, s57
    buffer_load_dwordx4 a[148:151], v25, s[8:11], s45 offen sc1
    v_mfma_f32_32x32x16_bf16 v[176:191], a[44:47], a[212:215], v[176:191]
    v_add_f32 v196, v196, v204
    v_add_f32 v197, v197, v205
    v_add_f32 v198, v198, v206
    v_add_f32 v199, v199, v207
    s_waitcnt vmcnt(8)
    v_mfma_f32_32x32x16_bf16 v[160:175], a[48:51], a[216:219], v[160:175]
    s_add_u32 s45, s45, s57
    buffer_load_dwordx4 a[152:155], v25, s[8:11], s45 offen sc1
    v_mfma_f32_32x32x16_bf16 v[176:191], a[52:55], a[216:219], v[176:191]
    s_waitcnt lgkmcnt(0)
    v_add_f32 v208, v208, v216
    v_add_f32 v209, v209, v217
    v_add_f32 v210, v210, v218
    v_add_f32 v211, v211, v219
    s_waitcnt vmcnt(8)
    v_mfma_f32_32x32x16_bf16 v[160:175], a[56:59], a[220:223], v[160:175]
    s_add_u32 s45, s45, s57
    buffer_load_dwordx4 a[156:159], v25, s[8:11], s45 offen sc1
    v_mfma_f32_32x32x16_bf16 v[176:191], a[60:63], a[220:223], v[176:191]
    v_add_f32 v212, v212, v220
    v_add_f32 v213, v213, v221
    v_add_f32 v214, v214, v222
    v_add_f32 v215, v215, v223
    s_waitcnt vmcnt(8)
    v_mfma_f32_32x32x16_bf16 v[160:175], a[64:67], a[128:131], v[160:175]
    v_add_f32 v192, v192, v208
    v_add_f32 v193, v193, v209
    v_add_f32 v194, v194, v210
    v_add_f32 v195, v195, v211
    v_mfma_f32_32x32x16_bf16 v[176:191], a[68:71], a[128:131], v[176:191]
    v_add_f32 v196, v196, v212
    v_add_f32 v197, v197, v213
    v_add_f32 v198, v198, v214
    v_add_f32 v199, v199, v215
    s_waitcnt vmcnt(7)
    v_mfma_f32_32x32x16_bf16 v[160:175], a[72:75], a[132:135], v[160:175]
    v_fmac_f32 v228, v192, v22
    v_fmac_f32 v229, v193, v22
    v_fmac_f32 v230, v194, v22
    v_fmac_f32 v231, v195, v22
    v_mfma_f32_32x32x16_bf16 v[176:191], a[76:79], a[132:135], v[176:191]
    v_fmac_f32 v232, v196, v22
    v_fmac_f32 v233, v197, v22
    v_fmac_f32 v234, v198, v22
    v_fmac_f32 v235, v199, v22
    s_waitcnt vmcnt(6)
    v_mfma_f32_32x32x16_bf16 v[160:175], a[80:83], a[136:139], v[160:175]
    v_cvt_pk_bf16_f32 v200, v228, v229
    v_cvt_pk_bf16_f32 v201, v230, v231
    v_cvt_pk_bf16_f32 v202, v232, v233
    v_cvt_pk_bf16_f32 v203, v234, v235
    v_mfma_f32_32x32x16_bf16 v[176:191], a[84:87], a[136:139], v[176:191]
    buffer_store_dwordx4 v[200:203], v10, s[16:19], s30 offen sc1
    s_waitcnt vmcnt(6)
    v_mfma_f32_32x32x16_bf16 v[160:175], a[88:91], a[140:143], v[160:175]
    v_mfma_f32_32x32x16_bf16 v[176:191], a[92:95], a[140:143], v[176:191]
    s_waitcnt vmcnt(4)
    v_mfma_f32_32x32x16_bf16 v[160:175], a[96:99], a[144:147], v[160:175]
    v_mfma_f32_32x32x16_bf16 v[176:191], a[100:103], a[144:147], v[176:191]
    s_waitcnt vmcnt(3)
    v_mfma_f32_32x32x16_bf16 v[160:175], a[104:107], a[148:151], v[160:175]
    v_mfma_f32_32x32x16_bf16 v[176:191], a[108:111], a[148:151], v[176:191]
    s_waitcnt vmcnt(2)
    v_mfma_f32_32x32x16_bf16 v[160:175], a[112:115], a[152:155], v[160:175]
    v_mfma_f32_32x32x16_bf16 v[176:191], a[116:119], a[152:155], v[176:191]
    s_waitcnt vmcnt(1)
    v_mfma_f32_32x32x16_bf16 v[160:175], a[120:123], a[156:159], v[160:175]
    v_mfma_f32_32x32x16_bf16 v[176:191], a[124:127], a[156:159], v[176:191]
    ds_read_b128 v[224:227], v24 offset:4096
    s_nop 9
    ds_write_b128 v12, v[160:163] offset:32768
    ds_write_b128 v13, v[164:167] offset:32768
    ds_write_b128 v14, v[168:171] offset:32768
    ds_write_b128 v15, v[172:175] offset:32768
    ds_write_b128 v16, v[176:179] offset:32768
    ds_write_b128 v17, v[180:183] offset:32768
    ds_write_b128 v18, v[184:187] offset:32768
    ds_write_b128 v19, v[188:191] offset:32768
    s_waitcnt lgkmcnt(0)
    s_barrier
    ds_read_b128 v[192:195], v20 offset:32768
    ds_read_b128 v[196:199], v21 offset:32768
    ds_read_b128 v[200:203], v20 offset:40960
    ds_read_b128 v[204:207], v21 offset:40960
    ds_read_b128 v[208:211], v20 offset:49152
    ds_read_b128 v[212:215], v21 offset:49152
    ds_read_b128 v[216:219], v20 offset:57344
    ds_read_b128 v[220:223], v21 offset:57344
    v_lshlrev_b32 v228, 16, v224
    v_and_b32 v229, 0xffff0000, v224
    v_lshlrev_b32 v230, 16, v225
    v_and_b32 v231, 0xffff0000, v225
    v_lshlrev_b32 v232, 16, v226
    v_and_b32 v233, 0xffff0000, v226
    v_lshlrev_b32 v234, 16, v227
    v_and_b32 v235, 0xffff0000, v227
    s_waitcnt lgkmcnt(4)
    v_pk_add_f32 v[192:193], v[192:193], v[200:201]
    v_pk_add_f32 v[194:195], v[194:195], v[202:203]
    v_pk_add_f32 v[196:197], v[196:197], v[204:205]
    v_pk_add_f32 v[198:199], v[198:199], v[206:207]
    s_waitcnt lgkmcnt(0)
    v_pk_add_f32 v[208:209], v[208:209], v[216:217]
    v_pk_add_f32 v[210:211], v[210:211], v[218:219]
    v_pk_add_f32 v[212:213], v[212:213], v[220:221]
    v_pk_add_f32 v[214:215], v[214:215], v[222:223]
    v_pk_add_f32 v[192:193], v[192:193], v[208:209]
    v_pk_add_f32 v[194:195], v[194:195], v[210:211]
    v_pk_add_f32 v[196:197], v[196:197], v[212:213]
    v_pk_add_f32 v[198:199], v[198:199], v[214:215]
    v_pk_fma_f32 v[228:229], v[192:193], v[22:23], v[228:229] op_sel:[0,1,0]
    v_pk_fma_f32 v[230:231], v[194:195], v[22:23], v[230:231] op_sel:[0,1,0]
    v_pk_fma_f32 v[232:233], v[196:197], v[22:23], v[232:233] op_sel:[0,1,0]
    v_pk_fma_f32 v[234:235], v[198:199], v[22:23], v[234:235] op_sel:[0,1,0]
    v_cvt_pk_bf16_f32 v200, v228, v229
    v_cvt_pk_bf16_f32 v201, v230, v231
    v_cvt_pk_bf16_f32 v202, v232, v233
    v_cvt_pk_bf16_f32 v203, v234, v235
    buffer_store_dwordx4 v[200:203], v10, s[16:19], s31 offen sc1
    s_endpgm
L_se_spare_2:
    s_sub_u32 s21, s2, 224
    v_lshlrev_b32 v3, 4, v1
    v_lshlrev_b32 v6, 7, v1
    s_waitcnt lgkmcnt(0)
    s_mov_b32 s8, s6
    s_and_b32 s9, s7, 0xffff
    s_mov_b32 s10, 11665408
    s_mov_b32 s11, 0x20000
    s_cmp_lt_u32 s21, 24
    s_cbranch_scc1 L_se_nz_24
    v_mov_b32 v108, 0
    v_mov_b32 v109, 0
    v_mov_b32 v110, 0
    v_mov_b32 v111, 0
    s_sub_u32 s34, s21, 24
    s_lshl2_add_u32 s33, s34, s20
    s_lshl_b32 s33, s33, 11
    s_add_u32 s33, s33, 11599872
    buffer_store_dwordx4 v[108:111], v3, s[8:11], s33 offen sc1
    buffer_store_dwordx4 v[108:111], v3, s[8:11], s33 offen offset:1024 sc1
    v_mov_b32 v2, 1
    s_lshl_b32 s34, s34, 2
    v_mov_b32 v5, s34
    s_waitcnt vmcnt(0)
    s_barrier
    s_cmp_lg_u32 s20, 0
    s_cbranch_scc1 L_se_skip_25
    s_mov_b64 exec, 1
    global_store_dword v5, v2, s[62:63] sc1
    s_mov_b64 exec, -1
L_se_skip_25:
L_se_nz_24:
    s_lshr_b32 s22, s21, 3
    s_lshl2_add_u32 s22, s22, s20
    s_lshl_b32 s23, s22, 13
    s_mov_b32 s12, s52
    s_and_b32 s13, s53, 0xffff
    s_mov_b32 s14, 1605632
    s_mov_b32 s15, 0x20000
    s_mov_b32 s16, s54
    s_and_b32 s17, s55, 0xffff
    s_mov_b32 s18, 1605632
    s_mov_b32 s19, 0x20000
    s_mov_b32 s24, s56
    s_and_b32 s25, s57, 0xffff
    s_mov_b32 s26, 1605632
    s_mov_b32 s27, 0x20000
    s_mov_b32 s28, s58
    s_and_b32 s29, s59, 0xffff
    s_mov_b32 s30, 1835008
    s_mov_b32 s31, 0x20000
    s_add_u32 s40, s23, 229376
    buffer_load_dword v8, v6, s[12:15], s40 offen
    buffer_load_dword v9, v6, s[16:19], s40 offen
    s_add_u32 s40, s23, 360448
    buffer_load_dword v10, v6, s[12:15], s40 offen
    buffer_load_dword v11, v6, s[16:19], s40 offen
    s_add_u32 s40, s23, 491520
    buffer_load_dword v12, v6, s[12:15], s40 offen
    buffer_load_dword v13, v6, s[16:19], s40 offen
    s_add_u32 s40, s23, 622592
    buffer_load_dword v14, v6, s[12:15], s40 offen
    buffer_load_dword v15, v6, s[16:19], s40 offen
    s_add_u32 s40, s23, 753664
    buffer_load_dword v16, v6, s[12:15], s40 offen
    buffer_load_dword v17, v6, s[16:19], s40 offen
    s_add_u32 s40, s23, 884736
    buffer_load_dword v18, v6, s[12:15], s40 offen
    buffer_load_dword v19, v6, s[16:19], s40 offen
    s_add_u32 s40, s23, 1015808
    buffer_load_dword v20, v6, s[12:15], s40 offen
    buffer_load_dword v21, v6, s[16:19], s40 offen
    s_add_u32 s40, s23, 1146880
    buffer_load_dword v22, v6, s[12:15], s40 offen
    buffer_load_dword v23, v6, s[16:19], s40 offen
    s_and_b32 s40, s2, 7
    s_mul_i32 s40, s40, 196608
    s_add_u32 s40, s40, s23
    buffer_load_dword v24, v6, s[24:27], s40 offen
    s_add_u32 s40, s40, 131072
    s_cmp_ge_u32 s40, 1703936
    s_cselect_b32 s41, 1703936, 0
    s_sub_u32 s40, s40, s41
    buffer_load_dword v25, v6, s[24:27], s40 offen
    s_add_u32 s40, s40, 131072
    s_cmp_ge_u32 s40, 1703936
    s_cselect_b32 s41, 1703936, 0
    s_sub_u32 s40, s40, s41
    buffer_load_dword v26, v6, s[24:27], s40 offen
    s_add_u32 s40, s40, 131072
    s_cmp_ge_u32 s40, 1703936
    s_cselect_b32 s41, 1703936, 0
    s_sub_u32 s40, s40, s41
    buffer_load_dword v27, v6, s[24:27], s40 offen
    s_add_u32 s40, s40, 131072
    s_cmp_ge_u32 s40, 1703936
    s_cselect_b32 s41, 1703936, 0
    s_sub_u32 s40, s40, s41
    buffer_load_dword v28, v6, s[24:27], s40 offen
    s_add_u32 s40, s40, 131072
    s_cmp_ge_u32 s40, 1703936
    s_cselect_b32 s41, 1703936, 0
    s_sub_u32 s40, s40, s41
    buffer_load_dword v29, v6, s[24:27], s40 offen
    s_add_u32 s40, s40, 131072
    s_cmp_ge_u32 s40, 1703936
    s_cselect_b32 s41, 1703936, 0
    s_sub_u32 s40, s40, s41
    buffer_load_dword v30, v6, s[24:27], s40 offen
    s_add_u32 s40, s40, 131072
    s_cmp_ge_u32 s40, 1703936
    s_cselect_b32 s41, 1703936, 0
    s_sub_u32 s40, s40, s41
    buffer_load_dword v31, v6, s[24:27], s40 offen
    s_add_u32 s40, s40, 131072
    s_cmp_ge_u32 s40, 1703936
    s_cselect_b32 s41, 1703936, 0
    s_sub_u32 s40, s40, s41
    buffer_load_dword v32, v6, s[24:27], s40 offen
    s_add_u32 s40, s40, 131072
    s_cmp_ge_u32 s40, 1703936
    s_cselect_b32 s41, 1703936, 0
    s_sub_u32 s40, s40, s41
    buffer_load_dword v33, v6, s[24:27], s40 offen
    s_add_u32 s40, s40, 131072
    s_cmp_ge_u32 s40, 1703936
    s_cselect_b32 s41, 1703936, 0
    s_sub_u32 s40, s40, s41
    buffer_load_dword v34, v6, s[24:27], s40 offen
    s_add_u32 s40, s40, 131072
    s_cmp_ge_u32 s40, 1703936
    s_cselect_b32 s41, 1703936, 0
    s_sub_u32 s40, s40, s41
    buffer_load_dword v35, v6, s[24:27], s40 offen
    s_add_u32 s40, s40, 131072
    s_cmp_ge_u32 s40, 1703936
    s_cselect_b32 s41, 1703936, 0
    s_sub_u32 s40, s40, s41
    buffer_load_dword v36, v6, s[24:27], s40 offen
    s_add_u32 s40, s40, 131072
    s_cmp_ge_u32 s40, 1703936
    s_cselect_b32 s41, 1703936, 0
    s_sub_u32 s40, s40, s41
    s_cmp_lg_u32 s22, 0
    s_cbranch_scc1 L_se_end_1
    v_lshlrev_b32 v3, 2, v1
    v_min_u32 v7, 28, v3
    global_load_dword v112, v7, s[62:63] sc1
    s_waitcnt vmcnt(0)
    v_cmp_eq_u32 vcc, 0, v112
    s_mov_b32 s50, 262144
    s_cbranch_vccnz L_se_poll_26
L_se_done_27:
    v_min_u32 v3, 220, v3
    s_and_b32 s22, s2, 7
    s_lshl_b32 s22, s22, 11
    s_add_u32 s22, s22, 11599872
    s_movk_i32 s23, 1024
    s_add_u32 s22, s22, 16384
L_se_wl_28:
    buffer_load_dword v4, v3, s[8:11], s22 offen offset:0 sc1
    buffer_load_dword v5, v3, s[8:11], s22 offen offset:1024 sc1
    s_sub_u32 s23, s23, 1
    s_waitcnt vmcnt(0)
    s_cmp_eq_u32 s23, 0
    s_cbranch_scc1 L_se_end_1
    v_and_b32 v4, v4, v5
    v_cmp_eq_u32 vcc, 0, v4
    s_nop 0
    s_cbranch_vccnz L_se_wl_28
    buffer_wbl2 sc1
    s_waitcnt vmcnt(0)
L_se_end_1:
    s_endpgm
L_se_poll_5:
    global_load_dword v31, v14, s[62:63] sc1
    s_sub_u32 s50, s50, 1
    s_waitcnt vmcnt(0)
    s_cmp_eq_u32 s50, 0
    s_cbranch_scc1 L_se_done_6
    v_cmp_eq_u32 vcc, 0, v31
    s_nop 0
    s_cbranch_vccnz L_se_poll_5
    s_branch L_se_done_6
L_se_poll_18:
    buffer_load_dword v31, v0, s[8:11], s33 offen offset:0 sc1
    s_sub_u32 s50, s50, 1
    s_waitcnt vmcnt(0)
    s_cmp_eq_u32 s50, 0
    s_cbranch_scc1 L_se_done_19
    v_cmp_eq_u32 vcc, 0, v31
    s_nop 0
    s_cbranch_vccnz L_se_poll_18
    s_branch L_se_done_19
L_se_poll_20:
    buffer_load_dword v31, v0, s[8:11], s33 offen offset:256 sc1
    s_sub_u32 s50, s50, 1
    s_waitcnt vmcnt(0)
    s_cmp_eq_u32 s50, 0
    s_cbranch_scc1 L_se_done_21
    v_cmp_eq_u32 vcc, 0, v31
    s_nop 0
    s_cbranch_vccnz L_se_poll_20
    s_branch L_se_done_21
L_se_poll_22:
    buffer_load_dword v31, v0, s[8:11], s33 offen offset:512 sc1
    s_sub_u32 s50, s50, 1
    s_waitcnt vmcnt(0)
    s_cmp_eq_u32 s50, 0
    s_cbranch_scc1 L_se_done_23
    v_cmp_eq_u32 vcc, 0, v31
    s_nop 0
    s_cbranch_vccnz L_se_poll_22
    s_branch L_se_done_23
L_se_poll_26:
    global_load_dword v112, v7, s[62:63] sc1
    s_sub_u32 s50, s50, 1
    s_waitcnt vmcnt(0)
    s_cmp_eq_u32 s50, 0
    s_cbranch_scc1 L_se_done_27
    v_cmp_eq_u32 vcc, 0, v112
    s_nop 0
    s_cbranch_vccnz L_se_poll_26
    s_branch L_se_done_27
L_se_slow_17:
    s_waitcnt vmcnt(17)
    s_barrier
    ds_read_b64_tr_b16 v[88:89], v14 offset:0
    ds_read_b64_tr_b16 v[90:91], v14 offset:512
    ds_read_b64_tr_b16 v[92:93], v15 offset:0
    ds_read_b64_tr_b16 v[94:95], v15 offset:512
    ds_read_b64_tr_b16 v[96:97], v16 offset:0
    ds_read_b64_tr_b16 v[98:99], v16 offset:512
    ds_read_b64_tr_b16 v[100:101], v17 offset:0
    ds_read_b64_tr_b16 v[102:103], v17 offset:512
    ds_read_b64_tr_b16 v[104:105], v14 offset:4096
    ds_read_b64_tr_b16 v[106:107], v14 offset:4608
    ds_read_b64_tr_b16 v[108:109], v15 offset:4096
    ds_read_b64_tr_b16 v[110:111], v15 offset:4608
    s_waitcnt lgkmcnt(10)
    v_mfma_f32_16x16x32_bf16 v[120:123], v[32:35], v[88:91], 0
    ds_read_b64_tr_b16 v[112:113], v16 offset:4096
    ds_read_b64_tr_b16 v[114:115], v16 offset:4608
    s_waitcnt lgkmcnt(10)
    v_mfma_f32_16x16x32_bf16 v[124:127], v[32:35], v[92:95], 0
    ds_read_b64_tr_b16 v[116:117], v17 offset:4096
    ds_read_b64_tr_b16 v[118:119], v17 offset:4608
    s_waitcnt lgkmcnt(10)
    v_mfma_f32_16x16x32_bf16 v[128:131], v[32:35], v[96:99], 0
    ds_read_b64_tr_b16 v[88:89], v14 offset:8192
    ds_read_b64_tr_b16 v[90:91], v14 offset:8704
    s_waitcnt lgkmcnt(10)
    v_mfma_f32_16x16x32_bf16 v[132:135], v[32:35], v[100:103], 0
    ds_read_b64_tr_b16 v[92:93], v15 offset:8192
    ds_read_b64_tr_b16 v[94:95], v15 offset:8704
    s_waitcnt lgkmcnt(10)
    v_mfma_f32_16x16x32_bf16 v[120:123], v[36:39], v[104:107], v[120:123]
    ds_read_b64_tr_b16 v[96:97], v16 offset:8192
    ds_read_b64_tr_b16 v[98:99], v16 offset:8704
    s_waitcnt lgkmcnt(10)
    v_mfma_f32_16x16x32_bf16 v[124:127], v[36:39], v[108:111], v[124:127]
    ds_read_b64_tr_b16 v[100:101], v17 offset:8192
    ds_read_b64_tr_b16 v[102:103], v17 offset:8704
    s_waitcnt lgkmcnt(10)
    v_mfma_f32_16x16x32_bf16 v[128:131], v[36:39], v[112:115], v[128:131]
    ds_read_b64_tr_b16 v[104:105], v14 offset:12288
    ds_read_b64_tr_b16 v[106:107], v14 offset:12800
    s_waitcnt lgkmcnt(10)
    v_mfma_f32_16x16x32_bf16 v[132:135], v[36:39], v[116:119], v[132:135]
    ds_read_b64_tr_b16 v[108:109], v15 offset:12288
    ds_read_b64_tr_b16 v[110:111], v15 offset:12800
    s_waitcnt lgkmcnt(10)
    v_mfma_f32_16x16x32_bf16 v[120:123], v[40:43], v[88:91], v[120:123]
    ds_read_b64_tr_b16 v[112:113], v16 offset:12288
    ds_read_b64_tr_b16 v[114:115], v16 offset:12800
    s_waitcnt lgkmcnt(10)
    v_mfma_f32_16x16x32_bf16 v[124:127], v[40:43], v[92:95], v[124:127]
    ds_read_b64_tr_b16 v[116:117], v17 offset:12288
    ds_read_b64_tr_b16 v[118:119], v17 offset:12800
    s_waitcnt lgkmcnt(10)
    v_mfma_f32_16x16x32_bf16 v[128:131], v[40:43], v[96:99], v[128:131]
    ds_read_b64_tr_b16 v[88:89], v14 offset:16384
    ds_read_b64_tr_b16 v[90:91], v14 offset:16896
    s_waitcnt lgkmcnt(10)
    v_mfma_f32_16x16x32_bf16 v[132:135], v[40:43], v[100:103], v[132:135]
    ds_read_b64_tr_b16 v[92:93], v15 offset:16384
    ds_read_b64_tr_b16 v[94:95], v15 offset:16896
    s_waitcnt lgkmcnt(10)
    v_mfma_f32_16x16x32_bf16 v[120:123], v[44:47], v[104:107], v[120:123]
    ds_read_b64_tr_b16 v[96:97], v16 offset:16384
    ds_read_b64_tr_b16 v[98:99], v16 offset:16896
    s_waitcnt lgkmcnt(10)
    v_mfma_f32_16x16x32_bf16 v[124:127], v[44:47], v[108:111], v[124:127]
    ds_read_b64_tr_b16 v[100:101], v17 offset:16384
    ds_read_b64_tr_b16 v[102:103], v17 offset:16896
    s_waitcnt lgkmcnt(10)
    v_mfma_f32_16x16x32_bf16 v[128:131], v[44:47], v[112:115], v[128:131]
    ds_read_b64_tr_b16 v[104:105], v14 offset:20480
    ds_read_b64_tr_b16 v[106:107], v14 offset:20992
    s_waitcnt lgkmcnt(10)
    v_mfma_f32_16x16x32_bf16 v[132:135], v[44:47], v[116:119], v[132:135]
    ds_read_b64_tr_b16 v[108:109], v15 offset:20480
    ds_read_b64_tr_b16 v[110:111], v15 offset:20992
    s_waitcnt lgkmcnt(10)
    v_mfma_f32_16x16x32_bf16 v[120:123], v[48:51], v[88:91], v[120:123]
    ds_read_b64_tr_b16 v[112:113], v16 offset:20480
    ds_read_b64_tr_b16 v[114:115], v16 offset:20992
    s_waitcnt lgkmcnt(10)
    v_mfma_f32_16x16x32_bf16 v[124:127], v[48:51], v[92:95], v[124:127]
    ds_read_b64_tr_b16 v[116:117], v17 offset:20480
    ds_read_b64_tr_b16 v[118:119], v17 offset:20992
    s_waitcnt lgkmcnt(10)
    v_mfma_f32_16x16x32_bf16 v[128:131], v[48:51], v[96:99], v[128:131]
    ds_read_b64_tr_b16 v[88:89], v14 offset:24576
    ds_read_b64_tr_b16 v[90:91], v14 offset:25088
    s_waitcnt lgkmcnt(10)
    v_mfma_f32_16x16x32_bf16 v[132:135], v[48:51], v[100:103], v[132:135]
    ds_read_b64_tr_b16 v[92:93], v15 offset:24576
    ds_read_b64_tr_b16 v[94:95], v15 offset:25088
    s_waitcnt lgkmcnt(10)
    v_mfma_f32_16x16x32_bf16 v[120:123], v[52:55], v[104:107], v[120:123]
    ds_read_b64_tr_b16 v[96:97], v16 offset:24576
    ds_read_b64_tr_b16 v[98:99], v16 offset:25088
    s_waitcnt lgkmcnt(10)
    v_mfma_f32_16x16x32_bf16 v[124:127], v[52:55], v[108:111], v[124:127]
    ds_read_b64_tr_b16 v[100:101], v17 offset:24576
    ds_read_b64_tr_b16 v[102:103], v17 offset:25088
    s_waitcnt lgkmcnt(10)
    v_mfma_f32_16x16x32_bf16 v[128:131], v[52:55], v[112:115], v[128:131]
    s_waitcnt vmcnt(8)
    s_barrier
    ds_read_b64_tr_b16 v[104:105], v60 offset:0
    ds_read_b64_tr_b16 v[106:107], v60 offset:512
    s_waitcnt lgkmcnt(10)
    v_mfma_f32_16x16x32_bf16 v[132:135], v[52:55], v[116:119], v[132:135]
    ds_read_b64_tr_b16 v[108:109], v61 offset:0
    ds_read_b64_tr_b16 v[110:111], v61 offset:512
    s_waitcnt lgkmcnt(10)
    v_mfma_f32_16x16x32_bf16 v[120:123], v[56:59], v[88:91], v[120:123]
    ds_read_b64_tr_b16 v[112:113], v62 offset:0
    ds_read_b64_tr_b16 v[114:115], v62 offset:512
    s_waitcnt lgkmcnt(10)
    v_mfma_f32_16x16x32_bf16 v[124:127], v[56:59], v[92:95], v[124:127]
    ds_read_b64_tr_b16 v[116:117], v63 offset:0
    ds_read_b64_tr_b16 v[118:119], v63 offset:512
    s_waitcnt lgkmcnt(10)
    v_mfma_f32_16x16x32_bf16 v[128:131], v[56:59], v[96:99], v[128:131]
    ds_read_b64_tr_b16 v[88:89], v60 offset:4096
    ds_read_b64_tr_b16 v[90:91], v60 offset:4608
    s_waitcnt lgkmcnt(10)
    v_mfma_f32_16x16x32_bf16 v[132:135], v[56:59], v[100:103], v[132:135]
    ds_read_b64_tr_b16 v[92:93], v61 offset:4096
    ds_read_b64_tr_b16 v[94:95], v61 offset:4608
    s_waitcnt lgkmcnt(10)
    v_mfma_f32_16x16x32_bf16 v[136:139], v[32:35], v[104:107], 0
    ds_read_b64_tr_b16 v[96:97], v62 offset:4096
    ds_read_b64_tr_b16 v[98:99], v62 offset:4608
    s_waitcnt lgkmcnt(10)
    v_mfma_f32_16x16x32_bf16 v[140:143], v[32:35], v[108:111], 0
    ds_read_b64_tr_b16 v[100:101], v63 offset:4096
    ds_read_b64_tr_b16 v[102:103], v63 offset:4608
    s_waitcnt lgkmcnt(10)
    v_mfma_f32_16x16x32_bf16 v[144:147], v[32:35], v[112:115], 0
    ds_read_b64_tr_b16 v[104:105], v60 offset:8192
    ds_read_b64_tr_b16 v[106:107], v60 offset:8704
    s_waitcnt lgkmcnt(10)
    v_mfma_f32_16x16x32_bf16 v[148:151], v[32:35], v[116:119], 0
    ds_read_b64_tr_b16 v[108:109], v61 offset:8192
    ds_read_b64_tr_b16 v[110:111], v61 offset:8704
    s_waitcnt lgkmcnt(10)
    v_mfma_f32_16x16x32_bf16 v[136:139], v[36:39], v[88:91], v[136:139]
    ds_read_b64_tr_b16 v[112:113], v62 offset:8192
    ds_read_b64_tr_b16 v[114:115], v62 offset:8704
    s_waitcnt lgkmcnt(10)
    v_mfma_f32_16x16x32_bf16 v[140:143], v[36:39], v[92:95], v[140:143]
    ds_read_b64_tr_b16 v[116:117], v63 offset:8192
    ds_read_b64_tr_b16 v[118:119], v63 offset:8704
    s_waitcnt lgkmcnt(10)
    v_mfma_f32_16x16x32_bf16 v[144:147], v[36:39], v[96:99], v[144:147]
    ds_read_b64_tr_b16 v[88:89], v60 offset:12288
    ds_read_b64_tr_b16 v[90:91], v60 offset:12800
    s_waitcnt lgkmcnt(10)
    v_mfma_f32_16x16x32_bf16 v[148:151], v[36:39], v[100:103], v[148:151]
    ds_read_b64_tr_b16 v[92:93], v61 offset:12288
    ds_read_b64_tr_b16 v[94:95], v61 offset:12800
    s_waitcnt lgkmcnt(10)
    v_mfma_f32_16x16x32_bf16 v[136:139], v[40:43], v[104:107], v[136:139]
    ds_read_b64_tr_b16 v[96:97], v62 offset:12288
    ds_read_b64_tr_b16 v[98:99], v62 offset:12800
    s_waitcnt lgkmcnt(10)
    v_mfma_f32_16x16x32_bf16 v[140:143], v[40:43], v[108:111], v[140:143]
    ds_read_b64_tr_b16 v[100:101], v63 offset:12288
    ds_read_b64_tr_b16 v[102:103], v63 offset:12800
    s_waitcnt lgkmcnt(10)
    v_mfma_f32_16x16x32_bf16 v[144:147], v[40:43], v[112:115], v[144:147]
    ds_read_b64_tr_b16 v[104:105], v60 offset:16384
    ds_read_b64_tr_b16 v[106:107], v60 offset:16896
    s_waitcnt lgkmcnt(10)
    v_mfma_f32_16x16x32_bf16 v[148:151], v[40:43], v[116:119], v[148:151]
    ds_read_b64_tr_b16 v[108:109], v61 offset:16384
    ds_read_b64_tr_b16 v[110:111], v61 offset:16896
    s_waitcnt lgkmcnt(10)
    v_mfma_f32_16x16x32_bf16 v[136:139], v[44:47], v[88:91], v[136:139]
    ds_read_b64_tr_b16 v[112:113], v62 offset:16384
    ds_read_b64_tr_b16 v[114:115], v62 offset:16896
    s_waitcnt lgkmcnt(10)
    v_mfma_f32_16x16x32_bf16 v[140:143], v[44:47], v[92:95], v[140:143]
    ds_read_b64_tr_b16 v[116:117], v63 offset:16384
    ds_read_b64_tr_b16 v[118:119], v63 offset:16896
    s_waitcnt lgkmcnt(10)
    v_mfma_f32_16x16x32_bf16 v[144:147], v[44:47], v[96:99], v[144:147]
    ds_read_b64_tr_b16 v[88:89], v60 offset:20480
    ds_read_b64_tr_b16 v[90:91], v60 offset:20992
    s_waitcnt lgkmcnt(10)
    v_mfma_f32_16x16x32_bf16 v[148:151], v[44:47], v[100:103], v[148:151]
    ds_read_b64_tr_b16 v[92:93], v61 offset:20480
    ds_read_b64_tr_b16 v[94:95], v61 offset:20992
    s_waitcnt lgkmcnt(10)
    v_mfma_f32_16x16x32_bf16 v[136:139], v[48:51], v[104:107], v[136:139]
    ds_read_b64_tr_b16 v[96:97], v62 offset:20480
    ds_read_b64_tr_b16 v[98:99], v62 offset:20992
    s_waitcnt lgkmcnt(10)
    v_mfma_f32_16x16x32_bf16 v[140:143], v[48:51], v[108:111], v[140:143]
    ds_read_b64_tr_b16 v[100:101], v63 offset:20480
    ds_read_b64_tr_b16 v[102:103], v63 offset:20992
    s_waitcnt lgkmcnt(10)
    v_mfma_f32_16x16x32_bf16 v[144:147], v[48:51], v[112:115], v[144:147]
    ds_read_b64_tr_b16 v[104:105], v60 offset:24576
    ds_read_b64_tr_b16 v[106:107], v60 offset:25088
    s_waitcnt lgkmcnt(10)
    v_mfma_f32_16x16x32_bf16 v[148:151], v[48:51], v[116:119], v[148:151]
    ds_read_b64_tr_b16 v[108:109], v61 offset:24576
    ds_read_b64_tr_b16 v[110:111], v61 offset:25088
    s_waitcnt lgkmcnt(10)
    v_mfma_f32_16x16x32_bf16 v[136:139], v[52:55], v[88:91], v[136:139]
    ds_read_b64_tr_b16 v[112:113], v62 offset:24576
    ds_read_b64_tr_b16 v[114:115], v62 offset:25088
    s_waitcnt lgkmcnt(10)
    v_mfma_f32_16x16x32_bf16 v[140:143], v[52:55], v[92:95], v[140:143]
    ds_read_b64_tr_b16 v[116:117], v63 offset:24576
    ds_read_b64_tr_b16 v[118:119], v63 offset:25088
    s_waitcnt lgkmcnt(10)
    v_mfma_f32_16x16x32_bf16 v[144:147], v[52:55], v[96:99], v[144:147]
    s_waitcnt lgkmcnt(8)
    v_mfma_f32_16x16x32_bf16 v[148:151], v[52:55], v[100:103], v[148:151]
    s_waitcnt lgkmcnt(6)
    v_mfma_f32_16x16x32_bf16 v[136:139], v[64:67], v[104:107], v[136:139]
    s_waitcnt lgkmcnt(4)
    v_mfma_f32_16x16x32_bf16 v[140:143], v[64:67], v[108:111], v[140:143]
    s_waitcnt lgkmcnt(2)
    v_mfma_f32_16x16x32_bf16 v[144:147], v[64:67], v[112:115], v[144:147]
    s_waitcnt lgkmcnt(0)
    v_mfma_f32_16x16x32_bf16 v[148:151], v[64:67], v[116:119], v[148:151]
    ds_read_b128 v[20:23], v18
    ds_read_b128 v[24:27], v18 offset:4096
    s_mul_i32 s26, s24, 56
    s_lshl2_add_u32 s27, s22, s20
    s_add_u32 s26, s26, s27
    s_lshl_b32 s26, s26, 10
    s_add_u32 s26, s26, 2097152
    s_add_u32 s27, s26, 28672
    v_pk_add_f32 v[120:121], v[120:121], v[136:137] neg_hi:[0,1]
    v_pk_add_f32 v[122:123], v[122:123], v[138:139] neg_hi:[0,1]
    v_pk_add_f32 v[124:125], v[124:125], v[140:141] neg_hi:[0,1]
    v_pk_add_f32 v[126:127], v[126:127], v[142:143] neg_hi:[0,1]
    v_pk_add_f32 v[128:129], v[128:129], v[144:145] neg_hi:[0,1]
    v_pk_add_f32 v[130:131], v[130:131], v[146:147] neg_hi:[0,1]
    v_pk_add_f32 v[132:133], v[132:133], v[148:149] neg_hi:[0,1]
    v_pk_add_f32 v[134:135], v[134:135], v[150:151] neg_hi:[0,1]
    v_xor_b32 v121, s59, v121
    v_xor_b32 v123, s59, v123
    v_xor_b32 v125, s59, v125
    v_xor_b32 v127, s59, v127
    v_xor_b32 v129, s59, v129
    v_xor_b32 v131, s59, v131
    v_xor_b32 v133, s59, v133
    v_xor_b32 v135, s59, v135
    v_permlane16_swap_b32 v120, v124
    v_permlane16_swap_b32 v121, v125
    v_permlane16_swap_b32 v122, v126
    v_permlane16_swap_b32 v123, v127
    v_permlane16_swap_b32 v128, v132
    v_permlane16_swap_b32 v129, v133
    v_permlane16_swap_b32 v130, v134
    v_permlane16_swap_b32 v131, v135
    s_waitcnt lgkmcnt(0)
    v_lshlrev_b32 v48, 16, v20
    v_and_b32 v49, 0xffff0000, v20
    v_lshlrev_b32 v50, 16, v21
    v_and_b32 v51, 0xffff0000, v21
    v_lshlrev_b32 v52, 16, v22
    v_and_b32 v53, 0xffff0000, v22
    v_lshlrev_b32 v54, 16, v23
    v_and_b32 v55, 0xffff0000, v23
    v_pk_add_f32 v[120:121], v[120:121], v[48:49]
    v_pk_add_f32 v[122:123], v[122:123], v[50:51]
    v_pk_add_f32 v[124:125], v[124:125], v[52:53]
    v_pk_add_f32 v[126:127], v[126:127], v[54:55]
    v_pk_add_f32 v[136:137], v[120:121], v[12:13] op_sel:[0,0] op_sel_hi:[1,0] neg_lo:[0,1] neg_hi:[0,1]
    v_pk_add_f32 v[138:139], v[122:123], v[12:13] op_sel:[0,0] op_sel_hi:[1,0] neg_lo:[0,1] neg_hi:[0,1]
    v_pk_add_f32 v[140:141], v[124:125], v[12:13] op_sel:[0,0] op_sel_hi:[1,0] neg_lo:[0,1] neg_hi:[0,1]
    v_pk_add_f32 v[142:143], v[126:127], v[12:13] op_sel:[0,0] op_sel_hi:[1,0] neg_lo:[0,1] neg_hi:[0,1]
    v_cvt_pk_bf16_f32 v40, v136, v137
    v_cvt_pk_bf16_f32 v41, v138, v139
    v_cvt_pk_bf16_f32 v42, v140, v141
    v_cvt_pk_bf16_f32 v43, v142, v143
    buffer_store_dwordx4 v[40:43], v3, s[8:11], s26 offen sc1
    v_lshlrev_b32 v48, 16, v24
    v_and_b32 v49, 0xffff0000, v24
    v_lshlrev_b32 v50, 16, v25
    v_and_b32 v51, 0xffff0000, v25
    v_lshlrev_b32 v52, 16, v26
    v_and_b32 v53, 0xffff0000, v26
    v_lshlrev_b32 v54, 16, v27
    v_and_b32 v55, 0xffff0000, v27
    v_pk_add_f32 v[128:129], v[128:129], v[48:49]
    v_pk_add_f32 v[130:131], v[130:131], v[50:51]
    v_pk_add_f32 v[132:133], v[132:133], v[52:53]
    v_pk_add_f32 v[134:135], v[134:135], v[54:55]
    v_pk_add_f32 v[144:145], v[128:129], v[12:13] op_sel:[0,1] op_sel_hi:[1,1] neg_lo:[0,1] neg_hi:[0,1]
    v_pk_add_f32 v[146:147], v[130:131], v[12:13] op_sel:[0,1] op_sel_hi:[1,1] neg_lo:[0,1] neg_hi:[0,1]
    v_pk_add_f32 v[148:149], v[132:133], v[12:13] op_sel:[0,1] op_sel_hi:[1,1] neg_lo:[0,1] neg_hi:[0,1]
    v_pk_add_f32 v[150:151], v[134:135], v[12:13] op_sel:[0,1] op_sel_hi:[1,1] neg_lo:[0,1] neg_hi:[0,1]
    v_cvt_pk_bf16_f32 v44, v144, v145
    v_cvt_pk_bf16_f32 v45, v146, v147
    v_cvt_pk_bf16_f32 v46, v148, v149
    v_cvt_pk_bf16_f32 v47, v150, v151
    buffer_store_dwordx4 v[44:47], v3, s[8:11], s27 offen sc1
    s_waitcnt vmcnt(2)
    s_barrier
    ds_read_b64_tr_b16 a[144:145], v252 offset:0
    ds_read_b64_tr_b16 a[146:147], v252 offset:1024
    ds_read_b64_tr_b16 a[148:149], v252 offset:4096
    ds_read_b64_tr_b16 a[150:151], v252 offset:5120
    ds_read_b64_tr_b16 a[152:153], v252 offset:8192
    ds_read_b64_tr_b16 a[154:155], v252 offset:9216
    ds_read_b64_tr_b16 a[156:157], v252 offset:12288
    ds_read_b64_tr_b16 a[158:159], v252 offset:13312
    ds_read_b64_tr_b16 a[160:161], v252 offset:16384
    ds_read_b64_tr_b16 a[162:163], v252 offset:17408
    ds_read_b64_tr_b16 a[164:165], v252 offset:20480
    ds_read_b64_tr_b16 a[166:167], v252 offset:21504
    ds_read_b64_tr_b16 a[168:169], v252 offset:24576
    ds_read_b64_tr_b16 a[170:171], v252 offset:25600
    ds_read_b64_tr_b16 a[172:173], v252 offset:28672
    ds_read_b64_tr_b16 a[174:175], v252 offset:29696
    ds_read_b64_tr_b16 a[176:177], v251 offset:0
    ds_read_b64_tr_b16 a[178:179], v251 offset:1024
    ds_read_b64_tr_b16 a[180:181], v251 offset:4096
    ds_read_b64_tr_b16 a[182:183], v251 offset:5120
    ds_read_b64_tr_b16 a[184:185], v251 offset:8192
    ds_read_b64_tr_b16 a[186:187], v251 offset:9216
    ds_read_b64_tr_b16 a[188:189], v251 offset:12288
    ds_read_b64_tr_b16 a[190:191], v251 offset:13312
    ds_read_b64_tr_b16 a[192:193], v251 offset:16384
    ds_read_b64_tr_b16 a[194:195], v251 offset:17408
    ds_read_b64_tr_b16 a[196:197], v251 offset:20480
    ds_read_b64_tr_b16 a[198:199], v251 offset:21504
    ds_read_b64_tr_b16 a[200:201], v251 offset:24576
    ds_read_b64_tr_b16 a[202:203], v251 offset:25600
    ds_read_b64_tr_b16 a[204:205], v251 offset:28672
    ds_read_b64_tr_b16 a[206:207], v251 offset:29696
    ds_read_b64_tr_b16 a[208:209], v251 offset:32768
    ds_read_b64_tr_b16 a[210:211], v251 offset:33792
    ds_read_b64_tr_b16 a[212:213], v251 offset:36864
    ds_read_b64_tr_b16 a[214:215], v251 offset:37888
    ds_read_b64_tr_b16 a[216:217], v251 offset:40960
    ds_read_b64_tr_b16 a[218:219], v251 offset:41984
    ds_read_b64_tr_b16 a[220:221], v251 offset:45056
    ds_read_b64_tr_b16 a[222:223], v251 offset:46080
    s_waitcnt vmcnt(0)
    s_waitcnt lgkmcnt(0)
    buffer_store_dword v2, off, s[8:11], s39 offset:0 sc1
    v_cvt_pk_bf16_f32 v32, v120, v121
    v_cvt_pk_bf16_f32 v33, v122, v123
    v_cvt_pk_bf16_f32 v34, v124, v125
    v_cvt_pk_bf16_f32 v35, v126, v127
    ds_write_b128 v18, v[32:35] offset:0
    v_cvt_pk_bf16_f32 v36, v128, v129
    v_cvt_pk_bf16_f32 v37, v130, v131
    v_cvt_pk_bf16_f32 v38, v132, v133
    v_cvt_pk_bf16_f32 v39, v134, v135
    ds_write_b128 v18, v[36:39] offset:4096
    v_mul_f32 v12, v136, v136
    v_mul_f32 v13, v144, v144
    v_fmac_f32 v12, v137, v137
    v_fmac_f32 v13, v145, v145
    v_fmac_f32 v12, v138, v138
    v_fmac_f32 v13, v146, v146
    v_fmac_f32 v12, v139, v139
    v_fmac_f32 v13, v147, v147
    v_fmac_f32 v12, v140, v140
    v_fmac_f32 v13, v148, v148
    v_fmac_f32 v12, v141, v141
    v_fmac_f32 v13, v149, v149
    v_fmac_f32 v12, v142, v142
    v_fmac_f32 v13, v150, v150
    v_fmac_f32 v12, v143, v143
    v_fmac_f32 v13, v151, v151
    s_lshl_b32 s26, s20, 8
    s_add_u32 s26, s26, 122880
    v_add_u32 v7, s26, v30
    v_permlane32_swap_b32 v12, v13
    v_add_f32 v12, v12, v13
    ds_write_b32 v7, v12
    s_mul_i32 s56, s21, 114688
    s_add_u32 s56, s56, 2097152
    s_mul_i32 s51, s20, 28672
    s_and_b32 s28, s20, 1
    s_mul_i32 s28, s28, 57344
    s_lshr_b32 s26, s20, 1
    s_lshl_b32 s52, s26, 10
    s_add_u32 s52, s52, s28
    s_add_u32 s53, s56, s51
    s_add_u32 s54, s56, s52
    s_add_u32 s53, s53, s3
    s_add_u32 s54, s54, s3
    v_add_u32 v6, 57344, v3
    s_mul_i32 s61, s24, 1792
    s_add_u32 s61, s61, 11542528
    v_add_u32 v7, 122880, v30
    s_mul_i32 s36, s21, 448
    s_lshl1_add_u32 s36, s25, s36
    s_lshl_b32 s36, s36, 10
    s_add_u32 s36, s36, 4194304
    v_lshlrev_b32 v11, 12, v4
    v_lshl_add_u32 v11, v5, 4, v11
    s_lshl_b32 s55, s21, 8
    s_mul_i32 s37, s24, 224
    s_mul_i32 s28, s20, 28
    s_add_u32 s37, s37, s28
    s_lshl_b32 s37, s37, 10
    s_add_u32 s37, s37, 4194304
    s_mul_i32 s34, s20, 401408
    s_lshl_b32 s28, s22, 7
    s_add_u32 s34, s34, s28
    s_add_u32 s46, s22, s24
    s_lshl_b32 s35, s20, 13
    s_add_u32 s35, s35, 123904
    v_and_b32 v12, 1, v4
    v_and_b32 v13, 7, v1
    v_lshlrev_b32 v14, 2, v12
    v_xor_b32 v13, v13, v14
    v_lshrrev_b32 v14, 3, v1
    v_mul_u32_u24 v14, 0x380, v14
    v_lshl_add_u32 v8, v13, 4, v14
    v_bfe_u32 v13, v1, 2, 2
    v_lshrrev_b32 v14, 5, v1
    v_lshl_add_u32 v14, v14, 2, v13
    v_lshrrev_b32 v13, 1, v13
    v_lshlrev_b32 v13, 6, v13
    v_lshl_add_u32 v13, v14, 7, v13
    v_lshl_add_u32 v13, v12, 5, v13
    v_and_b32 v14, 3, v1
    v_lshl_add_u32 v13, v14, 3, v13
    v_add_u32 v9, s35, v13
    v_xor_b32 v26, 64, v9
    v_add_u32 v56, s51, v13
    v_xor_b32 v57, 64, v56
    buffer_load_dword v31, v0, s[8:11], s33 offen offset:0 sc1
    s_waitcnt vmcnt(0)
    v_cmp_eq_u32 vcc, 0, v31
    s_mov_b32 s50, 262144
    s_cbranch_vccnz L_se_poll_29
L_se_done_30:
    s_add_u32 m0, s51, 0
    s_add_u32 s28, s53, 0
    buffer_load_dwordx4 v3, s[8:11], s28 offen sc1 lds
    s_add_u32 m0, s51, 1024
    s_add_u32 s28, s53, 1024
    buffer_load_dwordx4 v3, s[8:11], s28 offen sc1 lds
    s_add_u32 m0, s51, 2048
    s_add_u32 s28, s53, 2048
    buffer_load_dwordx4 v3, s[8:11], s28 offen sc1 lds
    s_add_u32 m0, s51, 3072
    s_add_u32 s28, s53, 3072
    buffer_load_dwordx4 v3, s[8:11], s28 offen sc1 lds
    s_add_u32 m0, s52, 4096
    s_add_u32 s28, s54, 4096
    buffer_load_dwordx4 v3, s[8:11], s28 offen sc1 lds
    s_add_u32 m0, s52, 6144
    s_add_u32 s28, s54, 6144
    buffer_load_dwordx4 v3, s[8:11], s28 offen sc1 lds
    s_add_u32 m0, s52, 8192
    s_add_u32 s28, s54, 8192
    buffer_load_dwordx4 v3, s[8:11], s28 offen sc1 lds
    s_waitcnt lgkmcnt(0)
    s_waitcnt vmcnt(4)
    s_barrier
    ds_read_b128 v[32:35], v3 offset:0
    ds_read_b128 v[36:39], v3 offset:28672
    ds_read_b128 v[40:43], v6 offset:0
    ds_read_b128 v[44:47], v6 offset:28672
    s_waitcnt lgkmcnt(2)
    v_mfma_f32_32x32x16_bf16 v[128:143], a[0:3], v[32:35], 0
    ds_read_b128 v[48:51], v3 offset:1024
    s_add_u32 m0, s52, 10240
    s_add_u32 s28, s54, 10240
    v_mfma_f32_32x32x16_bf16 v[144:159], a[4:7], v[32:35], 0
    buffer_load_dwordx4 v3, s[8:11], s28 offen sc1 lds
    ds_read2st64_b32 v[12:13], v7 offset1:1
    ds_read2st64_b32 v[14:15], v7 offset0:2 offset1:3
    s_lshl_b32 s26, s22, 8
    s_add_u32 s26, s26, s61
    v_mfma_f32_32x32x16_bf16 v[192:207], a[0:3], v[36:39], 0
    ds_read_b128 v[52:55], v3 offset:29696
    s_add_u32 m0, s35, 0
    s_add_u32 s44, s22, 0
    s_and_b32 s44, s44, 3
    s_mul_i32 s44, s44, 100352
    s_add_u32 s44, s44, s34
    v_mfma_f32_32x32x16_bf16 v[208:223], a[4:7], v[36:39], 0
    buffer_load_dwordx4 v8, s[40:43], s44 offen lds
    s_waitcnt lgkmcnt(4)
    v_mfma_f32_32x32x16_bf16 v[160:175], a[0:3], v[40:43], 0
    ds_read_b128 v[32:35], v6 offset:1024
    s_add_u32 m0, s52, 12288
    s_add_u32 s28, s54, 12288
    v_mfma_f32_32x32x16_bf16 v[176:191], a[4:7], v[40:43], 0
    buffer_load_dwordx4 v3, s[8:11], s28 offen sc1 lds
    v_mfma_f32_32x32x16_bf16 v[224:239], a[0:3], v[44:47], 0
    ds_read_b128 v[36:39], v6 offset:29696
    s_add_u32 m0, s35, 1024
    s_add_u32 s44, s44, 7168
    v_mfma_f32_32x32x16_bf16 v[240:255], a[4:7], v[44:47], 0
    buffer_load_dwordx4 v8, s[40:43], s44 offen lds
    s_waitcnt lgkmcnt(2)
    v_mfma_f32_32x32x16_bf16 v[128:143], a[8:11], v[48:51], v[128:143]
    ds_read_b128 v[40:43], v3 offset:2048
    s_add_u32 m0, s52, 14336
    s_add_u32 s28, s54, 14336
    v_mfma_f32_32x32x16_bf16 v[144:159], a[12:15], v[48:51], v[144:159]
    buffer_load_dwordx4 v3, s[8:11], s28 offen sc1 lds
    v_add_f32 v12, v12, v13
    v_add_f32 v14, v14, v15
    v_add_f32 v12, v12, v14
    buffer_store_dword v12, v30, s[8:11], s26 offen sc1
    v_mfma_f32_32x32x16_bf16 v[192:207], a[8:11], v[52:55], v[192:207]
    ds_read_b128 v[44:47], v3 offset:30720
    s_add_u32 m0, s52, 16384
    s_add_u32 s28, s54, 16384
    v_mfma_f32_32x32x16_bf16 v[208:223], a[12:15], v[52:55], v[208:223]
    buffer_load_dwordx4 v3, s[8:11], s28 offen sc1 lds
    s_waitcnt lgkmcnt(2)
    v_mfma_f32_32x32x16_bf16 v[160:175], a[8:11], v[32:35], v[160:175]
    ds_read_b128 v[48:51], v6 offset:2048
    s_add_u32 m0, s52, 18432
    s_add_u32 s28, s54, 18432
    v_mfma_f32_32x32x16_bf16 v[176:191], a[12:15], v[32:35], v[176:191]
    buffer_load_dwordx4 v3, s[8:11], s28 offen sc1 lds
    v_mfma_f32_32x32x16_bf16 v[224:239], a[8:11], v[36:39], v[224:239]
    ds_read_b128 v[52:55], v6 offset:30720
    s_add_u32 m0, s35, 2048
    s_add_u32 s44, s44, 7168
    v_mfma_f32_32x32x16_bf16 v[240:255], a[12:15], v[36:39], v[240:255]
    buffer_load_dwordx4 v8, s[40:43], s44 offen lds
    s_waitcnt vmcnt(9)
    s_barrier
    s_waitcnt lgkmcnt(2)
    v_mfma_f32_32x32x16_bf16 v[128:143], a[16:19], v[40:43], v[128:143]
    ds_read_b128 v[32:35], v3 offset:3072
    s_add_u32 m0, s52, 20480
    s_add_u32 s28, s54, 20480
    v_mfma_f32_32x32x16_bf16 v[144:159], a[20:23], v[40:43], v[144:159]
    buffer_load_dwordx4 v3, s[8:11], s28 offen sc1 lds
    v_mfma_f32_32x32x16_bf16 v[192:207], a[16:19], v[44:47], v[192:207]
    ds_read_b128 v[36:39], v3 offset:31744
    s_add_u32 m0, s35, 3072
    s_add_u32 s44, s44, 7168
    v_mfma_f32_32x32x16_bf16 v[208:223], a[20:23], v[44:47], v[208:223]
    buffer_load_dwordx4 v8, s[40:43], s44 offen lds
    s_waitcnt lgkmcnt(2)
    v_mfma_f32_32x32x16_bf16 v[160:175], a[16:19], v[48:51], v[160:175]
    ds_read_b128 v[40:43], v6 offset:3072
    s_add_u32 m0, s52, 22528
    s_add_u32 s28, s54, 22528
    v_mfma_f32_32x32x16_bf16 v[176:191], a[20:23], v[48:51], v[176:191]
    buffer_load_dwordx4 v3, s[8:11], s28 offen sc1 lds
    v_mfma_f32_32x32x16_bf16 v[224:239], a[16:19], v[52:55], v[224:239]
    ds_read_b128 v[44:47], v6 offset:31744
    s_waitcnt vmcnt(10)
    ds_read_b64_tr_b16 a[224:225], v9 offset:0
    s_add_u32 m0, s52, 24576
    s_add_u32 s28, s54, 24576
    v_mfma_f32_32x32x16_bf16 v[240:255], a[20:23], v[52:55], v[240:255]
    buffer_load_dwordx4 v3, s[8:11], s28 offen sc1 lds
    ds_read_b64_tr_b16 a[228:229], v26 offset:0
    s_waitcnt lgkmcnt(4)
    v_mfma_f32_32x32x16_bf16 v[128:143], a[24:27], v[32:35], v[128:143]
    ds_read_b128 v[48:51], v3 offset:4096
    s_add_u32 m0, s52, 26624
    s_add_u32 s28, s54, 26624
    v_mfma_f32_32x32x16_bf16 v[144:159], a[28:31], v[32:35], v[144:159]
    buffer_load_dwordx4 v3, s[8:11], s28 offen sc1 lds
    v_mfma_f32_32x32x16_bf16 v[192:207], a[24:27], v[36:39], v[192:207]
    ds_read_b128 v[52:55], v6 offset:4096
    s_waitcnt vmcnt(10)
    ds_read_b64_tr_b16 a[226:227], v9 offset:1024
    s_add_u32 m0, s35, 4096
    s_add_u32 s44, s44, 7168
    v_mfma_f32_32x32x16_bf16 v[208:223], a[28:31], v[36:39], v[208:223]
    buffer_load_dwordx4 v8, s[40:43], s44 offen lds
    ds_read_b64_tr_b16 a[230:231], v26 offset:1024
    s_waitcnt lgkmcnt(6)
    v_mfma_f32_32x32x16_bf16 v[160:175], a[24:27], v[40:43], v[160:175]
    ds_read_b128 v[32:35], v3 offset:5120
    s_add_u32 m0, s52, 32768
    s_add_u32 s28, s54, 32768
    v_mfma_f32_32x32x16_bf16 v[176:191], a[28:31], v[40:43], v[176:191]
    buffer_load_dwordx4 v3, s[8:11], s28 offen sc1 lds
    v_mfma_f32_32x32x16_bf16 v[224:239], a[24:27], v[44:47], v[224:239]
    ds_read_b128 v[36:39], v6 offset:5120
    s_add_u32 m0, s35, 5120
    s_add_u32 s44, s44, 7168
    v_mfma_f32_32x32x16_bf16 v[240:255], a[28:31], v[44:47], v[240:255]
    buffer_load_dwordx4 v8, s[40:43], s44 offen lds
    s_waitcnt lgkmcnt(4)
    v_mfma_f32_32x32x16_bf16 v[128:143], a[32:35], v[48:51], v[128:143]
    ds_read_b128 v[40:43], v3 offset:6144
    s_add_u32 m0, s35, 0
    s_add_u32 s44, s44, 7168
    v_mfma_f32_32x32x16_bf16 v[144:159], a[36:39], v[48:51], v[144:159]
    buffer_load_dwordx4 v8, s[40:43], s44 offen lds
    v_mfma_f32_32x32x16_bf16 v[160:175], a[32:35], v[52:55], v[160:175]
    ds_read_b128 v[44:47], v6 offset:6144
    s_waitcnt vmcnt(9)
    ds_read_b64_tr_b16 a[232:233], v9 offset:2048
    s_add_u32 m0, s52, 34816
    s_add_u32 s28, s54, 34816
    v_mfma_f32_32x32x16_bf16 v[176:191], a[36:39], v[52:55], v[176:191]
    buffer_load_dwordx4 v3, s[8:11], s28 offen sc1 lds
    ds_read_b64_tr_b16 a[236:237], v26 offset:2048
    s_barrier
    s_waitcnt lgkmcnt(4)
    v_mfma_f32_32x32x16_bf16 v[128:143], a[40:43], v[32:35], v[128:143]
    ds_read_b128 v[48:51], v3 offset:7168
    s_add_u32 m0, s35, 1024
    s_add_u32 s44, s44, 7168
    v_mfma_f32_32x32x16_bf16 v[144:159], a[44:47], v[32:35], v[144:159]
    buffer_load_dwordx4 v8, s[40:43], s44 offen lds
    v_mfma_f32_32x32x16_bf16 v[160:175], a[40:43], v[36:39], v[160:175]
    ds_read_b128 v[52:55], v6 offset:7168
    s_waitcnt vmcnt(9)
    ds_read_b64_tr_b16 a[234:235], v9 offset:3072
    s_add_u32 m0, s35, 6144
    s_add_u32 s44, s44, 7168
    v_mfma_f32_32x32x16_bf16 v[176:191], a[44:47], v[36:39], v[176:191]
    buffer_load_dwordx4 v8, s[40:43], s44 offen lds
    ds_read_b64_tr_b16 a[238:239], v26 offset:3072
    s_waitcnt lgkmcnt(6)
    v_mfma_f32_32x32x16_bf16 v[128:143], a[48:51], v[40:43], v[128:143]
    ds_read_b128 v[32:35], v3 offset:8192
    s_add_u32 m0, s52, 36864
    s_add_u32 s28, s54, 36864
    v_mfma_f32_32x32x16_bf16 v[144:159], a[52:55], v[40:43], v[144:159]
    buffer_load_dwordx4 v3, s[8:11], s28 offen sc1 lds
    v_mfma_f32_32x32x16_bf16 v[160:175], a[48:51], v[44:47], v[160:175]
    ds_read_b128 v[36:39], v6 offset:8192
    s_add_u32 m0, s35, 7168
    s_add_u32 s44, s44, 7168
    v_mfma_f32_32x32x16_bf16 v[176:191], a[52:55], v[44:47], v[176:191]
    buffer_load_dwordx4 v8, s[40:43], s44 offen lds
    s_waitcnt lgkmcnt(4)
    v_mfma_f32_32x32x16_bf16 v[128:143], a[56:59], v[48:51], v[128:143]
    ds_read_b128 v[40:43], v3 offset:9216
    s_add_u32 m0, s35, 2048
    s_add_u32 s44, s44, 7168
    v_mfma_f32_32x32x16_bf16 v[144:159], a[60:63], v[48:51], v[144:159]
    buffer_load_dwordx4 v8, s[40:43], s44 offen lds
    v_mfma_f32_32x32x16_bf16 v[160:175], a[56:59], v[52:55], v[160:175]
    ds_read_b128 v[44:47], v6 offset:9216
    s_waitcnt vmcnt(9)
    ds_read_b64_tr_b16 a[240:241], v9 offset:4096
    s_add_u32 m0, s52, 38912
    s_add_u32 s28, s54, 38912
    v_mfma_f32_32x32x16_bf16 v[176:191], a[60:63], v[52:55], v[176:191]
    buffer_load_dwordx4 v3, s[8:11], s28 offen sc1 lds
    ds_read_b64_tr_b16 a[244:245], v26 offset:4096
    s_barrier
    s_waitcnt lgkmcnt(4)
    v_mfma_f32_32x32x16_bf16 v[128:143], a[64:67], v[32:35], v[128:143]
    ds_read_b128 v[48:51], v3 offset:10240
    s_add_u32 m0, s35, 3072
    s_add_u32 s44, s44, 7168
    v_mfma_f32_32x32x16_bf16 v[144:159], a[68:71], v[32:35], v[144:159]
    buffer_load_dwordx4 v8, s[40:43], s44 offen lds
    v_mfma_f32_32x32x16_bf16 v[160:175], a[64:67], v[36:39], v[160:175]
    ds_read_b128 v[52:55], v6 offset:10240
    s_waitcnt vmcnt(9)
    ds_read_b64_tr_b16 a[242:243], v9 offset:5120
    s_add_u32 m0, s51, 0
    s_add_u32 s44, s44, 7168
    v_mfma_f32_32x32x16_bf16 v[176:191], a[68:71], v[36:39], v[176:191]
    buffer_load_dwordx4 v8, s[40:43], s44 offen lds
    ds_read_b64_tr_b16 a[246:247], v26 offset:5120
    s_waitcnt lgkmcnt(6)
    v_mfma_f32_32x32x16_bf16 v[128:143], a[72:75], v[40:43], v[128:143]
    ds_read_b128 v[32:35], v3 offset:11264
    s_waitcnt vmcnt(9)
    ds_read_b64_tr_b16 a[248:249], v9 offset:0
    s_add_u32 m0, s52, 40960
    s_add_u32 s28, s54, 40960
    v_mfma_f32_32x32x16_bf16 v[144:159], a[76:79], v[40:43], v[144:159]
    buffer_load_dwordx4 v3, s[8:11], s28 offen sc1 lds
    ds_read_b64_tr_b16 a[252:253], v26 offset:0
    v_mfma_f32_32x32x16_bf16 v[160:175], a[72:75], v[44:47], v[160:175]
    ds_read_b128 v[36:39], v6 offset:11264
    s_add_u32 m0, s51, 1024
    s_add_u32 s44, s44, 7168
    v_mfma_f32_32x32x16_bf16 v[176:191], a[76:79], v[44:47], v[176:191]
    buffer_load_dwordx4 v8, s[40:43], s44 offen lds
    s_waitcnt lgkmcnt(6)
    v_mfma_f32_32x32x16_bf16 v[128:143], a[80:83], v[48:51], v[128:143]
    ds_read_b128 v[40:43], v3 offset:12288
    s_waitcnt vmcnt(9)
    ds_read_b64_tr_b16 a[250:251], v9 offset:1024
    s_add_u32 m0, s35, 4096
    s_add_u32 s44, s22, 1
    s_and_b32 s44, s44, 3
    s_mul_i32 s44, s44, 100352
    s_add_u32 s44, s44, s34
    v_mfma_f32_32x32x16_bf16 v[144:159], a[84:87], v[48:51], v[144:159]
    buffer_load_dwordx4 v8, s[40:43], s44 offen lds
    ds_read_b64_tr_b16 a[254:255], v26 offset:1024
    v_mfma_f32_32x32x16_bf16 v[160:175], a[80:83], v[52:55], v[160:175]
    ds_read_b128 v[44:47], v6 offset:12288
    s_waitcnt vmcnt(9)
    ds_read_b64_tr_b16 v[64:65], v9 offset:6144
    s_add_u32 m0, s52, 43008
    s_add_u32 s28, s54, 43008
    v_mfma_f32_32x32x16_bf16 v[176:191], a[84:87], v[52:55], v[176:191]
    buffer_load_dwordx4 v3, s[8:11], s28 offen sc1 lds
    ds_read_b64_tr_b16 v[68:69], v26 offset:6144
    s_waitcnt lgkmcnt(6)
    v_mfma_f32_32x32x16_bf16 v[128:143], a[88:91], v[32:35], v[128:143]
    ds_read_b128 v[48:51], v3 offset:13312
    s_add_u32 m0, s35, 0
    s_add_u32 s44, s44, 7168
    v_mfma_f32_32x32x16_bf16 v[144:159], a[92:95], v[32:35], v[144:159]
    buffer_load_dwordx4 v8, s[40:43], s44 offen lds
    v_mfma_f32_32x32x16_bf16 v[160:175], a[88:91], v[36:39], v[160:175]
    ds_read_b128 v[52:55], v6 offset:13312
    s_waitcnt vmcnt(9)
    ds_read_b64_tr_b16 v[66:67], v9 offset:7168
    s_add_u32 m0, s35, 5120
    s_add_u32 s44, s44, 7168
    v_mfma_f32_32x32x16_bf16 v[176:191], a[92:95], v[36:39], v[176:191]
    buffer_load_dwordx4 v8, s[40:43], s44 offen lds
    ds_read_b64_tr_b16 v[70:71], v26 offset:7168
    s_waitcnt lgkmcnt(6)
    v_mfma_f32_32x32x16_bf16 v[128:143], a[96:99], v[40:43], v[128:143]
    ds_read_b128 v[32:35], v3 offset:14336
    s_waitcnt vmcnt(9)
    ds_read_b64_tr_b16 v[72:73], v9 offset:2048
    s_add_u32 m0, s52, 45056
    s_add_u32 s28, s54, 45056
    v_mfma_f32_32x32x16_bf16 v[144:159], a[100:103], v[40:43], v[144:159]
    buffer_load_dwordx4 v3, s[8:11], s28 offen sc1 lds
    ds_read_b64_tr_b16 v[76:77], v26 offset:2048
    v_mfma_f32_32x32x16_bf16 v[160:175], a[96:99], v[44:47], v[160:175]
    ds_read_b128 v[36:39], v6 offset:14336
    s_add_u32 m0, s35, 1024
    s_add_u32 s44, s44, 7168
    v_mfma_f32_32x32x16_bf16 v[176:191], a[100:103], v[44:47], v[176:191]
    buffer_load_dwordx4 v8, s[40:43], s44 offen lds
    s_waitcnt lgkmcnt(6)
    v_mfma_f32_32x32x16_bf16 v[128:143], a[104:107], v[48:51], v[128:143]
    ds_read_b128 v[40:43], v3 offset:15360
    s_waitcnt vmcnt(9)
    ds_read_b64_tr_b16 v[74:75], v9 offset:3072
    s_add_u32 m0, s35, 6144
    s_add_u32 s44, s44, 7168
    v_mfma_f32_32x32x16_bf16 v[144:159], a[108:111], v[48:51], v[144:159]
    buffer_load_dwordx4 v8, s[40:43], s44 offen lds
    ds_read_b64_tr_b16 v[78:79], v26 offset:3072
    v_mfma_f32_32x32x16_bf16 v[160:175], a[104:107], v[52:55], v[160:175]
    ds_read_b128 v[44:47], v6 offset:15360
    s_waitcnt vmcnt(9)
    ds_read_b64_tr_b16 v[80:81], v56 offset:0
    s_add_u32 m0, s52, 47104
    s_add_u32 s28, s54, 47104
    v_mfma_f32_32x32x16_bf16 v[176:191], a[108:111], v[52:55], v[176:191]
    buffer_load_dwordx4 v3, s[8:11], s28 offen sc1 lds
    ds_read_b64_tr_b16 v[84:85], v57 offset:0
    s_waitcnt lgkmcnt(6)
    v_mfma_f32_32x32x16_bf16 v[128:143], a[112:115], v[32:35], v[128:143]
    ds_read_b128 v[48:51], v3 offset:16384
    s_add_u32 m0, s35, 2048
    s_add_u32 s44, s44, 7168
    v_mfma_f32_32x32x16_bf16 v[144:159], a[116:119], v[32:35], v[144:159]
    buffer_load_dwordx4 v8, s[40:43], s44 offen lds
    v_mfma_f32_32x32x16_bf16 v[160:175], a[112:115], v[36:39], v[160:175]
    ds_read_b128 v[52:55], v6 offset:16384
    s_waitcnt vmcnt(9)
    ds_read_b64_tr_b16 v[82:83], v56 offset:1024
    s_add_u32 m0, s35, 7168
    s_add_u32 s44, s44, 7168
    v_mfma_f32_32x32x16_bf16 v[176:191], a[116:119], v[36:39], v[176:191]
    buffer_load_dwordx4 v8, s[40:43], s44 offen lds
    ds_read_b64_tr_b16 v[86:87], v57 offset:1024
    s_waitcnt lgkmcnt(6)
    v_mfma_f32_32x32x16_bf16 v[128:143], a[120:123], v[40:43], v[128:143]
    ds_read_b128 v[32:35], v3 offset:17408
    s_waitcnt vmcnt(9)
    ds_read_b64_tr_b16 v[88:89], v9 offset:4096
    s_add_u32 m0, s52, 49152
    s_add_u32 s28, s54, 49152
    v_mfma_f32_32x32x16_bf16 v[144:159], a[124:127], v[40:43], v[144:159]
    buffer_load_dwordx4 v3, s[8:11], s28 offen sc1 lds
    ds_read_b64_tr_b16 v[92:93], v26 offset:4096
    v_mfma_f32_32x32x16_bf16 v[160:175], a[120:123], v[44:47], v[160:175]
    ds_read_b128 v[36:39], v6 offset:17408
    s_add_u32 m0, s35, 3072
    s_add_u32 s44, s44, 7168
    v_mfma_f32_32x32x16_bf16 v[176:191], a[124:127], v[44:47], v[176:191]
    buffer_load_dwordx4 v8, s[40:43], s44 offen lds
    s_waitcnt lgkmcnt(6)
    v_mfma_f32_32x32x16_bf16 v[128:143], a[128:131], v[48:51], v[128:143]
    ds_read_b128 v[40:43], v3 offset:18432
    s_waitcnt vmcnt(9)
    ds_read_b64_tr_b16 v[90:91], v9 offset:0
    s_add_u32 m0, s51, 0
    s_add_u32 s44, s44, 7168
    v_mfma_f32_32x32x16_bf16 v[144:159], a[132:135], v[48:51], v[144:159]
    buffer_load_dwordx4 v8, s[40:43], s44 offen lds
    ds_read_b64_tr_b16 v[94:95], v26 offset:0
    v_mfma_f32_32x32x16_bf16 v[160:175], a[128:131], v[52:55], v[160:175]
    ds_read_b128 v[44:47], v6 offset:18432
    s_waitcnt vmcnt(9)
    ds_read_b64_tr_b16 v[96:97], v9 offset:5120
    s_add_u32 m0, s52, 51200
    s_add_u32 s28, s54, 51200
    v_mfma_f32_32x32x16_bf16 v[176:191], a[132:135], v[52:55], v[176:191]
    buffer_load_dwordx4 v3, s[8:11], s28 offen sc1 lds
    ds_read_b64_tr_b16 v[100:101], v26 offset:5120
    s_waitcnt lgkmcnt(6)
    v_mfma_f32_32x32x16_bf16 v[128:143], a[136:139], v[32:35], v[128:143]
    ds_read_b128 v[48:51], v3 offset:19456
    s_add_u32 m0, s35, 4096
    s_add_u32 s44, s44, 7168
    v_mfma_f32_32x32x16_bf16 v[144:159], a[140:143], v[32:35], v[144:159]
    buffer_load_dwordx4 v8, s[40:43], s44 offen lds
    v_mfma_f32_32x32x16_bf16 v[160:175], a[136:139], v[36:39], v[160:175]
    ds_read_b128 v[52:55], v6 offset:19456
    s_waitcnt vmcnt(9)
    ds_read_b64_tr_b16 v[98:99], v9 offset:1024
    s_add_u32 m0, s51, 1024
    s_add_u32 s44, s44, 7168
    v_mfma_f32_32x32x16_bf16 v[176:191], a[140:143], v[36:39], v[176:191]
    buffer_load_dwordx4 v8, s[40:43], s44 offen lds
    ds_read_b64_tr_b16 v[102:103], v26 offset:1024
    s_waitcnt lgkmcnt(6)
    v_mfma_f32_32x32x16_bf16 v[128:143], a[144:147], v[40:43], v[128:143]
    ds_read_b128 v[32:35], v3 offset:20480
    s_waitcnt vmcnt(9)
    ds_read_b64_tr_b16 v[104:105], v9 offset:6144
    s_add_u32 m0, s52, 53248
    s_add_u32 s28, s54, 53248
    v_mfma_f32_32x32x16_bf16 v[144:159], a[148:151], v[40:43], v[144:159]
    buffer_load_dwordx4 v3, s[8:11], s28 offen sc1 lds
    ds_read_b64_tr_b16 v[108:109], v26 offset:6144
    v_mfma_f32_32x32x16_bf16 v[160:175], a[144:147], v[44:47], v[160:175]
    ds_read_b128 v[36:39], v6 offset:20480
    s_add_u32 m0, s35, 0
    s_add_u32 s44, s44, 7168
    v_mfma_f32_32x32x16_bf16 v[176:191], a[148:151], v[44:47], v[176:191]
    buffer_load_dwordx4 v8, s[40:43], s44 offen lds
    s_waitcnt lgkmcnt(6)
    v_mfma_f32_32x32x16_bf16 v[128:143], a[152:155], v[48:51], v[128:143]
    ds_read_b128 v[40:43], v3 offset:21504
    s_waitcnt vmcnt(9)
    ds_read_b64_tr_b16 v[106:107], v9 offset:2048
    s_add_u32 m0, s35, 5120
    s_add_u32 s44, s44, 7168
    v_mfma_f32_32x32x16_bf16 v[144:159], a[156:159], v[48:51], v[144:159]
    buffer_load_dwordx4 v8, s[40:43], s44 offen lds
    ds_read_b64_tr_b16 v[110:111], v26 offset:2048
    v_mfma_f32_32x32x16_bf16 v[160:175], a[152:155], v[52:55], v[160:175]
    ds_read_b128 v[44:47], v6 offset:21504
    s_waitcnt vmcnt(9)
    ds_read_b64_tr_b16 v[112:113], v9 offset:7168
    s_add_u32 m0, s52, 55296
    s_add_u32 s28, s54, 55296
    v_mfma_f32_32x32x16_bf16 v[176:191], a[156:159], v[52:55], v[176:191]
    buffer_load_dwordx4 v3, s[8:11], s28 offen sc1 lds
    ds_read_b64_tr_b16 v[116:117], v26 offset:7168
    s_waitcnt lgkmcnt(6)
    v_mfma_f32_32x32x16_bf16 v[128:143], a[160:163], v[32:35], v[128:143]
    ds_read_b128 v[48:51], v3 offset:22528
    s_add_u32 m0, s35, 1024
    s_add_u32 s44, s44, 7168
    v_mfma_f32_32x32x16_bf16 v[144:159], a[164:167], v[32:35], v[144:159]
    buffer_load_dwordx4 v8, s[40:43], s44 offen lds
    v_mfma_f32_32x32x16_bf16 v[160:175], a[160:163], v[36:39], v[160:175]
    ds_read_b128 v[52:55], v6 offset:22528
    s_waitcnt vmcnt(9)
    ds_read_b64_tr_b16 v[114:115], v9 offset:3072
    s_add_u32 m0, s35, 6144
    s_add_u32 s44, s22, 2
    s_and_b32 s44, s44, 3
    s_mul_i32 s44, s44, 100352
    s_add_u32 s44, s44, s34
    v_mfma_f32_32x32x16_bf16 v[176:191], a[164:167], v[36:39], v[176:191]
    buffer_load_dwordx4 v8, s[40:43], s44 offen lds
    ds_read_b64_tr_b16 v[118:119], v26 offset:3072
    s_waitcnt lgkmcnt(6)
    v_mfma_f32_32x32x16_bf16 v[128:143], a[168:171], v[40:43], v[128:143]
    ds_read_b128 v[32:35], v3 offset:23552
    s_waitcnt vmcnt(9)
    ds_read_b64_tr_b16 v[120:121], v56 offset:0
    s_add_u32 m0, s35, 2048
    s_add_u32 s44, s44, 7168
    v_mfma_f32_32x32x16_bf16 v[144:159], a[172:175], v[40:43], v[144:159]
    buffer_load_dwordx4 v8, s[40:43], s44 offen lds
    ds_read_b64_tr_b16 v[124:125], v57 offset:0
    v_mfma_f32_32x32x16_bf16 v[160:175], a[168:171], v[44:47], v[160:175]
    ds_read_b128 v[36:39], v6 offset:23552
    s_add_u32 m0, s51, 2048
    s_add_u32 s44, s44, 7168
    v_mfma_f32_32x32x16_bf16 v[176:191], a[172:175], v[44:47], v[176:191]
    buffer_load_dwordx4 v8, s[40:43], s44 offen lds
    s_waitcnt lgkmcnt(6)
    v_mfma_f32_32x32x16_bf16 v[128:143], a[176:179], v[48:51], v[128:143]
    ds_read_b128 v[40:43], v3 offset:24576
    s_waitcnt vmcnt(9)
    ds_read_b64_tr_b16 v[122:123], v9 offset:4096
    s_add_u32 m0, s35, 7168
    s_add_u32 s44, s44, 7168
    v_mfma_f32_32x32x16_bf16 v[144:159], a[180:183], v[48:51], v[144:159]
    buffer_load_dwordx4 v8, s[40:43], s44 offen lds
    ds_read_b64_tr_b16 v[126:127], v26 offset:4096
    v_mfma_f32_32x32x16_bf16 v[160:175], a[176:179], v[52:55], v[160:175]
    ds_read_b128 v[44:47], v6 offset:24576
    s_waitcnt vmcnt(9)
    ds_read_b64_tr_b16 a[0:1], v56 offset:1024
    s_add_u32 m0, s51, 3072
    s_add_u32 s44, s44, 7168
    v_mfma_f32_32x32x16_bf16 v[176:191], a[180:183], v[52:55], v[176:191]
    buffer_load_dwordx4 v8, s[40:43], s44 offen lds
    ds_read_b64_tr_b16 a[4:5], v57 offset:1024
    s_waitcnt lgkmcnt(6)
    v_mfma_f32_32x32x16_bf16 v[128:143], a[184:187], v[32:35], v[128:143]
    ds_read_b128 v[48:51], v3 offset:25600
    s_add_u32 m0, s35, 3072
    s_add_u32 s44, s44, 7168
    v_mfma_f32_32x32x16_bf16 v[144:159], a[188:191], v[32:35], v[144:159]
    buffer_load_dwordx4 v8, s[40:43], s44 offen lds
    v_mfma_f32_32x32x16_bf16 v[160:175], a[184:187], v[36:39], v[160:175]
    ds_read_b128 v[52:55], v6 offset:25600
    s_waitcnt vmcnt(9)
    ds_read_b64_tr_b16 a[2:3], v9 offset:0
    s_add_u32 m0, s51, 0
    s_add_u32 s44, s44, 7168
    v_mfma_f32_32x32x16_bf16 v[176:191], a[188:191], v[36:39], v[176:191]
    buffer_load_dwordx4 v8, s[40:43], s44 offen lds
    ds_read_b64_tr_b16 a[6:7], v26 offset:0
    s_waitcnt lgkmcnt(6)
    v_mfma_f32_32x32x16_bf16 v[128:143], a[192:195], v[40:43], v[128:143]
    ds_read_b128 v[32:35], v3 offset:26624
    s_waitcnt vmcnt(9)
    ds_read_b64_tr_b16 a[8:9], v9 offset:5120
    s_add_u32 m0, s35, 4096
    s_add_u32 s44, s44, 7168
    v_mfma_f32_32x32x16_bf16 v[144:159], a[196:199], v[40:43], v[144:159]
    buffer_load_dwordx4 v8, s[40:43], s44 offen lds
    ds_read_b64_tr_b16 a[12:13], v26 offset:5120
    v_mfma_f32_32x32x16_bf16 v[160:175], a[192:195], v[44:47], v[160:175]
    ds_read_b128 v[36:39], v6 offset:26624
    v_mfma_f32_32x32x16_bf16 v[176:191], a[196:199], v[44:47], v[176:191]
    s_waitcnt lgkmcnt(6)
    v_mfma_f32_32x32x16_bf16 v[128:143], a[200:203], v[48:51], v[128:143]
    ds_read_b128 v[40:43], v3 offset:27648
    s_waitcnt vmcnt(8)
    ds_read_b64_tr_b16 a[10:11], v9 offset:1024
    s_add_u32 m0, s51, 1024
    s_add_u32 s44, s44, 7168
    v_mfma_f32_32x32x16_bf16 v[144:159], a[204:207], v[48:51], v[144:159]
    buffer_load_dwordx4 v8, s[40:43], s44 offen lds
    ds_read_b64_tr_b16 a[14:15], v26 offset:1024
    v_mfma_f32_32x32x16_bf16 v[160:175], a[200:203], v[52:55], v[160:175]
    ds_read_b128 v[44:47], v6 offset:27648
    s_waitcnt vmcnt(8)
    ds_read_b64_tr_b16 a[16:17], v9 offset:6144
    v_mfma_f32_32x32x16_bf16 v[176:191], a[204:207], v[52:55], v[176:191]
    ds_read_b64_tr_b16 a[20:21], v26 offset:6144
    s_barrier
    s_waitcnt lgkmcnt(6)
    v_mfma_f32_32x32x16_bf16 v[128:143], a[208:211], v[32:35], v[128:143]
    ds_read_b128 v[48:51], v3 offset:32768
    s_waitcnt vmcnt(7)
    ds_read_b64_tr_b16 a[18:19], v9 offset:2048
    s_add_u32 m0, s35, 0
    s_add_u32 s44, s44, 7168
    v_mfma_f32_32x32x16_bf16 v[144:159], a[212:215], v[32:35], v[144:159]
    buffer_load_dwordx4 v8, s[40:43], s44 offen lds
    ds_read_b64_tr_b16 a[22:23], v26 offset:2048
    v_mfma_f32_32x32x16_bf16 v[160:175], a[208:211], v[36:39], v[160:175]
    ds_read_b128 v[52:55], v6 offset:32768
    s_waitcnt vmcnt(7)
    ds_read_b64_tr_b16 a[24:25], v56 offset:2048
    s_add_u32 m0, s35, 5120
    s_add_u32 s44, s44, 7168
    v_mfma_f32_32x32x16_bf16 v[176:191], a[212:215], v[36:39], v[176:191]
    buffer_load_dwordx4 v8, s[40:43], s44 offen lds
    ds_read_b64_tr_b16 a[28:29], v57 offset:2048
    s_waitcnt lgkmcnt(8)
    v_mfma_f32_32x32x16_bf16 v[128:143], a[216:219], v[40:43], v[128:143]
    ds_read_b128 v[32:35], v3 offset:33792
    s_waitcnt vmcnt(7)
    ds_read_b64_tr_b16 a[26:27], v9 offset:7168
    s_add_u32 m0, s35, 1024
    s_add_u32 s44, s44, 7168
    v_mfma_f32_32x32x16_bf16 v[144:159], a[220:223], v[40:43], v[144:159]
    buffer_load_dwordx4 v8, s[40:43], s44 offen lds
    ds_read_b64_tr_b16 a[30:31], v26 offset:7168
    v_mfma_f32_32x32x16_bf16 v[160:175], a[216:219], v[44:47], v[160:175]
    ds_read_b128 v[36:39], v6 offset:33792
    v_mfma_f32_32x32x16_bf16 v[176:191], a[220:223], v[44:47], v[176:191]
    s_waitcnt lgkmcnt(6)
    v_mfma_f32_32x32x16_bf16 v[192:207], a[32:35], v[48:51], v[192:207]
    ds_read_b128 v[40:43], v3 offset:34816
    s_add_u32 m0, s35, 2048
    s_add_u32 s44, s44, 7168
    v_mfma_f32_32x32x16_bf16 v[208:223], a[36:39], v[48:51], v[208:223]
    buffer_load_dwordx4 v8, s[40:43], s44 offen lds
    v_mfma_f32_32x32x16_bf16 v[224:239], a[32:35], v[52:55], v[224:239]
    ds_read_b128 v[44:47], v6 offset:34816
    v_mul_f32 v144, v128, v144
    v_mul_f32 v145, v129, v145
    s_add_u32 m0, s35, 6144
    s_add_u32 s44, s44, 7168
    v_mfma_f32_32x32x16_bf16 v[240:255], a[36:39], v[52:55], v[240:255]
    buffer_load_dwordx4 v8, s[40:43], s44 offen lds
    v_mul_f32 v146, v130, v146
    v_mul_f32 v147, v131, v147
    v_cvt_pk_bf16_f32 v128, v144, v145
    s_waitcnt lgkmcnt(2)
    v_mfma_f32_32x32x16_bf16 v[192:207], a[40:43], v[32:35], v[192:207]
    ds_read_b128 v[48:51], v3 offset:35840
    s_waitcnt vmcnt(9)
    ds_read_b64_tr_b16 a[32:33], v56 offset:3072
    v_mul_f32 v148, v132, v148
    v_mul_f32 v149, v133, v149
    v_cvt_pk_bf16_f32 v129, v146, v147
    s_add_u32 m0, s35, 7168
    s_add_u32 s44, s22, 3
    s_and_b32 s44, s44, 3
    s_mul_i32 s44, s44, 100352
    s_add_u32 s44, s44, s34
    v_mfma_f32_32x32x16_bf16 v[208:223], a[44:47], v[32:35], v[208:223]
    buffer_load_dwordx4 v8, s[40:43], s44 offen lds
    v_mul_f32 v150, v134, v150
    v_mul_f32 v151, v135, v151
    v_cvt_pk_bf16_f32 v130, v148, v149
    v_mfma_f32_32x32x16_bf16 v[224:239], a[40:43], v[36:39], v[224:239]
    ds_read_b128 v[52:55], v6 offset:35840
    ds_read_b64_tr_b16 a[36:37], v57 offset:3072
    v_mul_f32 v152, v136, v152
    v_mul_f32 v153, v137, v153
    v_cvt_pk_bf16_f32 v131, v150, v151
    s_add_u32 m0, s51, 2048
    s_add_u32 s44, s44, 7168
    v_mfma_f32_32x32x16_bf16 v[240:255], a[44:47], v[36:39], v[240:255]
    buffer_load_dwordx4 v8, s[40:43], s44 offen lds
    s_add_u32 s38, s36, 0
    buffer_store_dwordx4 v[128:131], v3, s[8:11], s38 offen offset:0 sc1
    s_waitcnt lgkmcnt(4)
    v_mfma_f32_32x32x16_bf16 v[192:207], a[48:51], v[40:43], v[192:207]
    ds_read_b128 v[32:35], v3 offset:36864
    s_waitcnt vmcnt(11)
    ds_read_b64_tr_b16 a[34:35], v9 offset:3072
    v_mul_f32 v154, v138, v154
    v_mul_f32 v155, v139, v155
    v_cvt_pk_bf16_f32 v132, v152, v153
    v_mfma_f32_32x32x16_bf16 v[208:223], a[52:55], v[40:43], v[208:223]
    v_mul_f32 v156, v140, v156
    v_mul_f32 v157, v141, v157
    v_cvt_pk_bf16_f32 v133, v154, v155
    v_mfma_f32_32x32x16_bf16 v[224:239], a[48:51], v[44:47], v[224:239]
    ds_read_b128 v[36:39], v6 offset:36864
    ds_read_b64_tr_b16 a[38:39], v26 offset:3072
    v_mul_f32 v158, v142, v158
    v_mul_f32 v159, v143, v159
    v_cvt_pk_bf16_f32 v134, v156, v157
    v_mfma_f32_32x32x16_bf16 v[240:255], a[52:55], v[44:47], v[240:255]
    v_mul_f32 v176, v160, v176
    v_mul_f32 v177, v161, v177
    v_cvt_pk_bf16_f32 v135, v158, v159
    s_waitcnt lgkmcnt(5)
    v_mfma_f32_32x32x16_bf16 v[192:207], a[56:59], v[48:51], v[192:207]
    ds_read_b128 v[40:43], v3 offset:37888
    s_waitcnt vmcnt(10)
    ds_read_b64_tr_b16 a[40:41], v56 offset:0
    buffer_store_dwordx4 v[132:135], v3, s[8:11], s38 offen offset:1024 sc1
    v_mfma_f32_32x32x16_bf16 v[208:223], a[60:63], v[48:51], v[208:223]
    v_mul_f32 v178, v162, v178
    v_mul_f32 v179, v163, v179
    v_cvt_pk_bf16_f32 v160, v176, v177
    v_mfma_f32_32x32x16_bf16 v[224:239], a[56:59], v[52:55], v[224:239]
    ds_read_b128 v[44:47], v6 offset:37888
    ds_read_b64_tr_b16 a[44:45], v57 offset:0
    v_mul_f32 v180, v164, v180
    v_mul_f32 v181, v165, v181
    v_cvt_pk_bf16_f32 v161, v178, v179
    v_mfma_f32_32x32x16_bf16 v[240:255], a[60:63], v[52:55], v[240:255]
    v_mul_f32 v182, v166, v182
    v_mul_f32 v183, v167, v183
    v_cvt_pk_bf16_f32 v162, v180, v181
    s_waitcnt lgkmcnt(5)
    v_mfma_f32_32x32x16_bf16 v[192:207], a[64:67], v[32:35], v[192:207]
    ds_read_b128 v[48:51], v3 offset:38912
    s_waitcnt vmcnt(10)
    ds_read_b64_tr_b16 a[42:43], v9 offset:4096
    v_mul_f32 v184, v168, v184
    v_mul_f32 v185, v169, v185
    v_cvt_pk_bf16_f32 v163, v182, v183
    s_add_u32 m0, s51, 3072
    s_add_u32 s44, s44, 7168
    v_mfma_f32_32x32x16_bf16 v[208:223], a[68:71], v[32:35], v[208:223]
    buffer_load_dwordx4 v8, s[40:43], s44 offen lds
    s_add_u32 s38, s36, 229376
    buffer_store_dwordx4 v[160:163], v3, s[8:11], s38 offen offset:0 sc1
    v_mfma_f32_32x32x16_bf16 v[224:239], a[64:67], v[36:39], v[224:239]
    ds_read_b128 v[52:55], v6 offset:38912
    ds_read_b64_tr_b16 a[46:47], v26 offset:4096
    v_mul_f32 v186, v170, v186
    v_mul_f32 v187, v171, v187
    v_cvt_pk_bf16_f32 v164, v184, v185
    v_mfma_f32_32x32x16_bf16 v[240:255], a[68:71], v[36:39], v[240:255]
    v_mul_f32 v188, v172, v188
    v_mul_f32 v189, v173, v189
    v_cvt_pk_bf16_f32 v165, v186, v187
    s_waitcnt lgkmcnt(5)
    v_mfma_f32_32x32x16_bf16 v[192:207], a[72:75], v[40:43], v[192:207]
    ds_read_b128 v[32:35], v3 offset:39936
    s_waitcnt vmcnt(11)
    ds_read_b64_tr_b16 a[48:49], v56 offset:1024
    v_mul_f32 v190, v174, v190
    v_mul_f32 v191, v175, v191
    v_cvt_pk_bf16_f32 v166, v188, v189
    s_add_u32 m0, s35, 3072
    s_add_u32 s44, s44, 7168
    v_mfma_f32_32x32x16_bf16 v[208:223], a[76:79], v[40:43], v[208:223]
    buffer_load_dwordx4 v8, s[40:43], s44 offen lds
    v_cvt_pk_bf16_f32 v167, v190, v191
    v_mfma_f32_32x32x16_bf16 v[224:239], a[72:75], v[44:47], v[224:239]
    ds_read_b128 v[36:39], v6 offset:39936
    ds_read_b64_tr_b16 a[52:53], v57 offset:1024
    buffer_store_dwordx4 v[164:167], v3, s[8:11], s38 offen offset:1024 sc1
    v_mfma_f32_32x32x16_bf16 v[240:255], a[76:79], v[44:47], v[240:255]
    s_waitcnt lgkmcnt(5)
    v_mfma_f32_32x32x16_bf16 v[192:207], a[80:83], v[48:51], v[192:207]
    ds_read_b128 v[40:43], v3 offset:40960
    s_waitcnt vmcnt(12)
    ds_read_b64_tr_b16 a[50:51], v9 offset:0
    s_add_u32 m0, s51, 0
    s_add_u32 s44, s44, 7168
    v_mfma_f32_32x32x16_bf16 v[208:223], a[84:87], v[48:51], v[208:223]
    buffer_load_dwordx4 v8, s[40:43], s44 offen lds
    ds_read_b64_tr_b16 a[54:55], v26 offset:0
    v_mfma_f32_32x32x16_bf16 v[224:239], a[80:83], v[52:55], v[224:239]
    ds_read_b128 v[44:47], v6 offset:40960
    s_waitcnt vmcnt(12)
    ds_read_b64_tr_b16 a[56:57], v9 offset:5120
    v_mfma_f32_32x32x16_bf16 v[240:255], a[84:87], v[52:55], v[240:255]
    ds_read_b64_tr_b16 a[60:61], v26 offset:5120
    s_waitcnt lgkmcnt(7)
    v_mfma_f32_32x32x16_bf16 v[192:207], a[88:91], v[32:35], v[192:207]
    ds_read_b128 v[48:51], v3 offset:41984
    s_waitcnt vmcnt(11)
    ds_read_b64_tr_b16 a[58:59], v9 offset:1024
    s_add_u32 m0, s35, 4096
    s_add_u32 s44, s44, 7168
    v_mfma_f32_32x32x16_bf16 v[208:223], a[92:95], v[32:35], v[208:223]
    buffer_load_dwordx4 v8, s[40:43], s44 offen lds
    ds_read_b64_tr_b16 a[62:63], v26 offset:1024
    v_mfma_f32_32x32x16_bf16 v[224:239], a[88:91], v[36:39], v[224:239]
    ds_read_b128 v[52:55], v6 offset:41984
    s_waitcnt vmcnt(11)
    ds_read_b64_tr_b16 a[64:65], v9 offset:2048
    v_mfma_f32_32x32x16_bf16 v[240:255], a[92:95], v[36:39], v[240:255]
    ds_read_b64_tr_b16 a[68:69], v26 offset:2048
    s_waitcnt lgkmcnt(8)
    v_mfma_f32_32x32x16_bf16 v[192:207], a[96:99], v[40:43], v[192:207]
    ds_read_b128 v[32:35], v3 offset:43008
    s_waitcnt vmcnt(10)
    ds_read_b64_tr_b16 a[66:67], v9 offset:6144
    s_add_u32 m0, s35, 0
    s_add_u32 s44, s44, 7168
    v_mfma_f32_32x32x16_bf16 v[208:223], a[100:103], v[40:43], v[208:223]
    buffer_load_dwordx4 v8, s[40:43], s44 offen lds
    ds_read_b64_tr_b16 a[70:71], v26 offset:6144
    v_mfma_f32_32x32x16_bf16 v[224:239], a[96:99], v[44:47], v[224:239]
    ds_read_b128 v[36:39], v6 offset:43008
    s_waitcnt vmcnt(10)
    ds_read_b64_tr_b16 a[72:73], v9 offset:7168
    s_add_u32 m0, s51, 1024
    s_add_u32 s44, s44, 7168
    v_mfma_f32_32x32x16_bf16 v[240:255], a[100:103], v[44:47], v[240:255]
    buffer_load_dwordx4 v8, s[40:43], s44 offen lds
    ds_read_b64_tr_b16 a[76:77], v26 offset:7168
    s_waitcnt lgkmcnt(8)
    v_mfma_f32_32x32x16_bf16 v[192:207], a[104:107], v[48:51], v[192:207]
    ds_read_b128 v[40:43], v3 offset:44032
    s_waitcnt vmcnt(10)
    ds_read_b64_tr_b16 a[74:75], v56 offset:2048
    s_add_u32 m0, s35, 1024
    s_add_u32 s44, s44, 7168
    v_mfma_f32_32x32x16_bf16 v[208:223], a[108:111], v[48:51], v[208:223]
    buffer_load_dwordx4 v8, s[40:43], s44 offen lds
    ds_read_b64_tr_b16 a[78:79], v57 offset:2048
    v_mfma_f32_32x32x16_bf16 v[224:239], a[104:107], v[52:55], v[224:239]
    ds_read_b128 v[44:47], v6 offset:44032
    s_add_u32 m0, s35, 5120
    s_add_u32 s44, s44, 7168
    v_mfma_f32_32x32x16_bf16 v[240:255], a[108:111], v[52:55], v[240:255]
    buffer_load_dwordx4 v8, s[40:43], s44 offen lds
    s_waitcnt lgkmcnt(6)
    v_mfma_f32_32x32x16_bf16 v[192:207], a[112:115], v[32:35], v[192:207]
    ds_read_b128 v[48:51], v3 offset:45056
    s_add_u32 m0, s35, 2048
    s_add_u32 s44, s44, 7168
    v_mfma_f32_32x32x16_bf16 v[208:223], a[116:119], v[32:35], v[208:223]
    buffer_load_dwordx4 v8, s[40:43], s44 offen lds
    v_mfma_f32_32x32x16_bf16 v[224:239], a[112:115], v[36:39], v[224:239]
    ds_read_b128 v[52:55], v6 offset:45056
    s_add_u32 m0, s35, 6144
    s_add_u32 s44, s44, 7168
    v_mfma_f32_32x32x16_bf16 v[240:255], a[116:119], v[36:39], v[240:255]
    buffer_load_dwordx4 v8, s[40:43], s44 offen lds
    s_waitcnt lgkmcnt(2)
    v_mfma_f32_32x32x16_bf16 v[192:207], a[120:123], v[40:43], v[192:207]
    ds_read_b128 v[32:35], v3 offset:46080
    s_add_u32 m0, s35, 7168
    s_add_u32 s44, s44, 7168
    v_mfma_f32_32x32x16_bf16 v[208:223], a[124:127], v[40:43], v[208:223]
    buffer_load_dwordx4 v8, s[40:43], s44 offen lds
    v_mfma_f32_32x32x16_bf16 v[224:239], a[120:123], v[44:47], v[224:239]
    ds_read_b128 v[36:39], v6 offset:46080
    s_add_u32 m0, s51, 2048
    s_add_u32 s44, s44, 7168
    v_mfma_f32_32x32x16_bf16 v[240:255], a[124:127], v[44:47], v[240:255]
    buffer_load_dwordx4 v8, s[40:43], s44 offen lds
    s_waitcnt lgkmcnt(2)
    v_mfma_f32_32x32x16_bf16 v[192:207], a[128:131], v[48:51], v[192:207]
    ds_read_b128 v[40:43], v3 offset:47104
    v_mfma_f32_32x32x16_bf16 v[208:223], a[132:135], v[48:51], v[208:223]
    v_mfma_f32_32x32x16_bf16 v[224:239], a[128:131], v[52:55], v[224:239]
    ds_read_b128 v[44:47], v6 offset:47104
    v_mfma_f32_32x32x16_bf16 v[240:255], a[132:135], v[52:55], v[240:255]
    s_waitcnt lgkmcnt(2)
    v_mfma_f32_32x32x16_bf16 v[192:207], a[136:139], v[32:35], v[192:207]
    ds_read_b128 v[48:51], v3 offset:48128
    s_waitcnt vmcnt(13)
    ds_read_b64_tr_b16 a[80:81], v56 offset:3072
    v_mfma_f32_32x32x16_bf16 v[208:223], a[140:143], v[32:35], v[208:223]
    ds_read_b64_tr_b16 a[84:85], v57 offset:3072
    v_mfma_f32_32x32x16_bf16 v[224:239], a[136:139], v[36:39], v[224:239]
    ds_read_b128 v[52:55], v6 offset:48128
    v_mfma_f32_32x32x16_bf16 v[240:255], a[140:143], v[36:39], v[240:255]
    s_waitcnt lgkmcnt(4)
    v_mfma_f32_32x32x16_bf16 v[192:207], a[144:147], v[40:43], v[192:207]
    ds_read_b128 v[32:35], v3 offset:49152
    s_waitcnt vmcnt(11)
    ds_read_b64_tr_b16 a[82:83], v9 offset:3072
    v_mfma_f32_32x32x16_bf16 v[208:223], a[148:151], v[40:43], v[208:223]
    ds_read_b64_tr_b16 a[86:87], v26 offset:3072
    v_mfma_f32_32x32x16_bf16 v[224:239], a[144:147], v[44:47], v[224:239]
    ds_read_b128 v[36:39], v6 offset:49152
    v_mfma_f32_32x32x16_bf16 v[240:255], a[148:151], v[44:47], v[240:255]
    s_waitcnt vmcnt(10)
    buffer_store_dword v2, off, s[8:11], s39 offset:256 sc1
    s_waitcnt lgkmcnt(4)
    v_mfma_f32_32x32x16_bf16 v[192:207], a[152:155], v[48:51], v[192:207]
    ds_read_b128 v[40:43], v3 offset:50176
    v_mfma_f32_32x32x16_bf16 v[208:223], a[156:159], v[48:51], v[208:223]
    v_mfma_f32_32x32x16_bf16 v[224:239], a[152:155], v[52:55], v[224:239]
    ds_read_b128 v[44:47], v6 offset:50176
    s_waitcnt vmcnt(10)
    ds_read_b64_tr_b16 a[88:89], v56 offset:0
    v_mfma_f32_32x32x16_bf16 v[240:255], a[156:159], v[52:55], v[240:255]
    ds_read_b64_tr_b16 a[92:93], v57 offset:0
    s_waitcnt lgkmcnt(4)
    v_mfma_f32_32x32x16_bf16 v[192:207], a[160:163], v[32:35], v[192:207]
    ds_read_b128 v[48:51], v3 offset:51200
    s_waitcnt vmcnt(9)
    ds_read_b64_tr_b16 a[90:91], v9 offset:4096
    v_mfma_f32_32x32x16_bf16 v[208:223], a[164:167], v[32:35], v[208:223]
    ds_read_b64_tr_b16 a[94:95], v26 offset:4096
    v_mfma_f32_32x32x16_bf16 v[224:239], a[160:163], v[36:39], v[224:239]
    ds_read_b128 v[52:55], v6 offset:51200
    s_waitcnt vmcnt(8)
    ds_read_b64_tr_b16 a[96:97], v9 offset:0
    v_mfma_f32_32x32x16_bf16 v[240:255], a[164:167], v[36:39], v[240:255]
    ds_read_b64_tr_b16 a[100:101], v26 offset:0
    s_waitcnt lgkmcnt(8)
    v_mfma_f32_32x32x16_bf16 v[192:207], a[168:171], v[40:43], v[192:207]
    ds_read_b128 v[32:35], v3 offset:52224
    s_waitcnt vmcnt(7)
    ds_read_b64_tr_b16 a[98:99], v56 offset:1024
    v_mfma_f32_32x32x16_bf16 v[208:223], a[172:175], v[40:43], v[208:223]
    ds_read_b64_tr_b16 a[102:103], v57 offset:1024
    v_mfma_f32_32x32x16_bf16 v[224:239], a[168:171], v[44:47], v[224:239]
    ds_read_b128 v[36:39], v6 offset:52224
    s_waitcnt vmcnt(6)
    ds_read_b64_tr_b16 a[104:105], v9 offset:1024
    v_mfma_f32_32x32x16_bf16 v[240:255], a[172:175], v[44:47], v[240:255]
    ds_read_b64_tr_b16 a[108:109], v26 offset:1024
    s_waitcnt lgkmcnt(8)
    v_mfma_f32_32x32x16_bf16 v[192:207], a[176:179], v[48:51], v[192:207]
    ds_read_b128 v[40:43], v3 offset:53248
    s_waitcnt vmcnt(5)
    ds_read_b64_tr_b16 a[106:107], v9 offset:5120
    v_mfma_f32_32x32x16_bf16 v[208:223], a[180:183], v[48:51], v[208:223]
    ds_read_b64_tr_b16 a[110:111], v26 offset:5120
    v_mfma_f32_32x32x16_bf16 v[224:239], a[176:179], v[52:55], v[224:239]
    ds_read_b128 v[44:47], v6 offset:53248
    s_waitcnt vmcnt(4)
    ds_read_b64_tr_b16 a[112:113], v9 offset:2048
    v_mfma_f32_32x32x16_bf16 v[240:255], a[180:183], v[52:55], v[240:255]
    ds_read_b64_tr_b16 a[116:117], v26 offset:2048
    buffer_load_dword v31, v0, s[8:11], s33 offen offset:256 sc1
    s_waitcnt lgkmcnt(8)
    v_mfma_f32_32x32x16_bf16 v[192:207], a[184:187], v[32:35], v[192:207]
    ds_read_b128 v[48:51], v3 offset:54272
    s_waitcnt vmcnt(4)
    ds_read_b64_tr_b16 a[114:115], v9 offset:6144
    v_mfma_f32_32x32x16_bf16 v[208:223], a[188:191], v[32:35], v[208:223]
    ds_read_b64_tr_b16 a[118:119], v26 offset:6144
    v_mfma_f32_32x32x16_bf16 v[224:239], a[184:187], v[36:39], v[224:239]
    ds_read_b128 v[52:55], v6 offset:54272
    s_waitcnt vmcnt(3)
    ds_read_b64_tr_b16 a[120:121], v9 offset:7168
    v_mfma_f32_32x32x16_bf16 v[240:255], a[188:191], v[36:39], v[240:255]
    ds_read_b64_tr_b16 a[124:125], v26 offset:7168
    s_waitcnt lgkmcnt(8)
    v_mfma_f32_32x32x16_bf16 v[192:207], a[192:195], v[40:43], v[192:207]
    ds_read_b128 v[32:35], v3 offset:55296
    s_waitcnt vmcnt(2)
    ds_read_b64_tr_b16 a[122:123], v56 offset:2048
    v_mfma_f32_32x32x16_bf16 v[208:223], a[196:199], v[40:43], v[208:223]
    ds_read_b64_tr_b16 a[126:127], v57 offset:2048
    v_mfma_f32_32x32x16_bf16 v[224:239], a[192:195], v[44:47], v[224:239]
    ds_read_b128 v[36:39], v6 offset:55296
    v_mfma_f32_32x32x16_bf16 v[240:255], a[196:199], v[44:47], v[240:255]
    s_waitcnt vmcnt(0)
    v_cmp_eq_u32 vcc, 0, v31
    s_mov_b32 s50, 262144
    s_cbranch_vccnz L_se_poll_31
L_se_done_32:
    s_waitcnt lgkmcnt(6)
    v_mfma_f32_32x32x16_bf16 v[192:207], a[200:203], v[48:51], v[192:207]
    ds_read_b128 v[40:43], v3 offset:56320
    s_add_u32 s45, s22, 0
    s_and_b32 s45, s45, 3
    s_mul_i32 s45, s45, 7168
    s_add_u32 s45, s45, s37
    v_mfma_f32_32x32x16_bf16 v[208:223], a[204:207], v[48:51], v[208:223]
    buffer_load_dwordx4 a[128:131], v3, s[8:11], s45 offen offset:0 sc1
    v_mfma_f32_32x32x16_bf16 v[224:239], a[200:203], v[52:55], v[224:239]
    ds_read_b128 v[44:47], v6 offset:56320
    v_mfma_f32_32x32x16_bf16 v[240:255], a[204:207], v[52:55], v[240:255]
    buffer_load_dwordx4 a[132:135], v3, s[8:11], s45 offen offset:1024 sc1
    s_waitcnt lgkmcnt(2)
    v_mfma_f32_32x32x16_bf16 v[192:207], a[208:211], v[32:35], v[192:207]
    v_mfma_f32_32x32x16_bf16 v[208:223], a[212:215], v[32:35], v[208:223]
    buffer_load_dwordx4 a[136:139], v3, s[8:11], s45 offen offset:2048 sc1
    v_mfma_f32_32x32x16_bf16 v[224:239], a[208:211], v[36:39], v[224:239]
    v_mfma_f32_32x32x16_bf16 v[240:255], a[212:215], v[36:39], v[240:255]
    buffer_load_dwordx4 a[140:143], v3, s[8:11], s45 offen offset:3072 sc1
    s_waitcnt lgkmcnt(0)
    v_mfma_f32_32x32x16_bf16 v[192:207], a[216:219], v[40:43], v[192:207]
    s_add_u32 s45, s45, 4096
    v_mfma_f32_32x32x16_bf16 v[208:223], a[220:223], v[40:43], v[208:223]
    buffer_load_dwordx4 a[144:147], v3, s[8:11], s45 offen offset:0 sc1
    v_mfma_f32_32x32x16_bf16 v[224:239], a[216:219], v[44:47], v[224:239]
    v_mfma_f32_32x32x16_bf16 v[240:255], a[220:223], v[44:47], v[240:255]
    buffer_load_dwordx4 a[148:151], v3, s[8:11], s45 offen offset:1024 sc1
    buffer_load_dwordx4 a[152:155], v3, s[8:11], s45 offen offset:2048 sc1
    s_nop 6
    v_mul_f32 v208, v192, v208
    v_mul_f32 v209, v193, v209
    v_mul_f32 v210, v194, v210
    v_mul_f32 v211, v195, v211
    v_cvt_pk_bf16_f32 v192, v208, v209
    s_add_u32 s45, s22, 1
    s_and_b32 s45, s45, 3
    s_mul_i32 s45, s45, 7168
    s_add_u32 s45, s45, s37
    buffer_load_dwordx4 a[156:159], v3, s[8:11], s45 offen offset:0 sc1
    v_mul_f32 v212, v196, v212
    v_mul_f32 v213, v197, v213
    v_cvt_pk_bf16_f32 v193, v210, v211
    v_mul_f32 v214, v198, v214
    v_mul_f32 v215, v199, v215
    v_cvt_pk_bf16_f32 v194, v212, v213
    v_mul_f32 v216, v200, v216
    v_mul_f32 v217, v201, v217
    v_cvt_pk_bf16_f32 v195, v214, v215
    s_lshl_b32 s38, s25, 15
    s_add_u32 s38, s38, s55
    buffer_store_dwordx4 v[192:195], v11, s[8:11], s38 offen offset:0 sc1
    v_mul_f32 v218, v202, v218
    v_mul_f32 v219, v203, v219
    v_cvt_pk_bf16_f32 v196, v216, v217
    v_mul_f32 v220, v204, v220
    v_mul_f32 v221, v205, v221
    v_cvt_pk_bf16_f32 v197, v218, v219
    v_mul_f32 v222, v206, v222
    v_mul_f32 v223, v207, v223
    v_cvt_pk_bf16_f32 v198, v220, v221
    v_mul_f32 v240, v224, v240
    v_mul_f32 v241, v225, v241
    v_cvt_pk_bf16_f32 v199, v222, v223
    s_add_u32 s38, s38, 16384
    buffer_store_dwordx4 v[196:199], v11, s[8:11], s38 offen offset:0 sc1
    v_mul_f32 v242, v226, v242
    v_mul_f32 v243, v227, v243
    v_cvt_pk_bf16_f32 v224, v240, v241
    v_mul_f32 v244, v228, v244
    v_mul_f32 v245, v229, v245
    v_cvt_pk_bf16_f32 v225, v242, v243
    v_mul_f32 v246, v230, v246
    v_mul_f32 v247, v231, v247
    v_cvt_pk_bf16_f32 v226, v244, v245
    v_mul_f32 v248, v232, v248
    v_mul_f32 v249, v233, v249
    v_cvt_pk_bf16_f32 v227, v246, v247
    s_lshl_b32 s38, s25, 11
    s_add_u32 s38, s38, s56
    buffer_store_dwordx4 v[224:227], v3, s[8:11], s38 offen offset:0 sc1
    v_mul_f32 v250, v234, v250
    v_mul_f32 v251, v235, v251
    v_cvt_pk_bf16_f32 v228, v248, v249
    v_mul_f32 v252, v236, v252
    v_mul_f32 v253, v237, v253
    v_cvt_pk_bf16_f32 v229, v250, v251
    v_mul_f32 v254, v238, v254
    v_mul_f32 v255, v239, v255
    v_cvt_pk_bf16_f32 v230, v252, v253
    v_cvt_pk_bf16_f32 v231, v254, v255
    buffer_store_dwordx4 v[228:231], v3, s[8:11], s38 offen offset:1024 sc1
    s_waitcnt vmcnt(11)
    v_mfma_f32_32x32x16_bf16 v[128:143], a[224:227], a[128:131], 0
    buffer_load_dwordx4 a[160:163], v3, s[8:11], s45 offen offset:1024 sc1
    v_mfma_f32_32x32x16_bf16 v[144:159], a[228:231], a[128:131], 0
    v_and_b32 v6, 31, v1
    v_lshrrev_b32 v7, 5, v1
    v_and_b32 v27, 7, v1
    v_xor_b32 v7, v7, v27
    s_waitcnt vmcnt(11)
    v_mfma_f32_32x32x16_bf16 v[128:143], a[232:235], a[132:135], v[128:143]
    buffer_load_dwordx4 a[164:167], v3, s[8:11], s45 offen offset:2048 sc1
    v_mfma_f32_32x32x16_bf16 v[144:159], a[236:239], a[132:135], v[144:159]
    s_lshl_b32 s26, s20, 13
    v_lshlrev_b32 v7, 4, v7
    v_lshl_add_u32 v7, v6, 8, v7
    v_add_u32 v12, s26, v7
    s_waitcnt vmcnt(11)
    v_mfma_f32_32x32x16_bf16 v[128:143], a[240:243], a[136:139], v[128:143]
    buffer_load_dwordx4 a[168:171], v3, s[8:11], s45 offen offset:3072 sc1
    v_mfma_f32_32x32x16_bf16 v[144:159], a[244:247], a[136:139], v[144:159]
    v_xor_b32 v13, 32, v12
    v_xor_b32 v14, 64, v12
    v_xor_b32 v15, 96, v12
    v_xor_b32 v16, 128, v12
    s_waitcnt vmcnt(11)
    v_mfma_f32_32x32x16_bf16 v[128:143], a[248:251], a[140:143], v[128:143]
    s_add_u32 s45, s45, 4096
    buffer_load_dwordx4 a[172:175], v3, s[8:11], s45 offen offset:0 sc1
    v_mfma_f32_32x32x16_bf16 v[144:159], a[252:255], a[140:143], v[144:159]
    v_xor_b32 v17, 160, v12
    v_xor_b32 v18, 192, v12
    v_xor_b32 v19, 224, v12
    s_waitcnt vmcnt(11)
    v_mfma_f32_32x32x16_bf16 v[128:143], v[64:67], a[144:147], v[128:143]
    buffer_load_dwordx4 a[176:179], v3, s[8:11], s45 offen offset:1024 sc1
    v_mfma_f32_32x32x16_bf16 v[144:159], v[68:71], a[144:147], v[144:159]
    v_lshrrev_b32 v6, 3, v1
    s_and_b32 s26, s20, 1
    s_lshl_b32 s26, s26, 2
    v_xor_b32 v7, v27, v4
    v_xor_b32 v7, s26, v7
    s_waitcnt vmcnt(11)
    v_mfma_f32_32x32x16_bf16 v[128:143], v[72:75], a[148:151], v[128:143]
    buffer_load_dwordx4 a[180:183], v3, s[8:11], s45 offen offset:2048 sc1
    v_mfma_f32_32x32x16_bf16 v[144:159], v[76:79], a[148:151], v[144:159]
    v_lshlrev_b32 v7, 1, v7
    v_xor_b32 v7, v7, v6
    s_lshl_b32 s26, s20, 11
    v_lshlrev_b32 v7, 4, v7
    s_waitcnt vmcnt(11)
    v_mfma_f32_32x32x16_bf16 v[128:143], v[80:83], a[152:155], v[128:143]
    s_add_u32 s45, s22, 2
    s_and_b32 s45, s45, 3
    s_mul_i32 s45, s45, 7168
    s_add_u32 s45, s45, s37
    buffer_load_dwordx4 a[184:187], v3, s[8:11], s45 offen offset:0 sc1
    v_mfma_f32_32x32x16_bf16 v[144:159], v[84:87], a[152:155], v[144:159]
    v_lshl_add_u32 v7, v6, 8, v7
    v_add_u32 v20, s26, v7
    v_xor_b32 v21, 16, v20
    s_waitcnt vmcnt(11)
    v_mfma_f32_32x32x16_bf16 v[128:143], v[88:91], a[156:159], v[128:143]
    buffer_load_dwordx4 a[188:191], v3, s[8:11], s45 offen offset:1024 sc1
    v_mfma_f32_32x32x16_bf16 v[144:159], v[92:95], a[156:159], v[144:159]
    s_lshl_b32 s26, s20, 10
    s_add_u32 s26, s26, 114688
    v_add_u32 v24, s26, v3
    s_lshl_b32 s26, s20, 5
    v_lshl_add_u32 v28, v6, 2, s26
    s_waitcnt vmcnt(8)
    buffer_store_dword v2, off, s[8:11], s39 offset:512 sc1
    s_waitcnt vmcnt(8)
    v_mfma_f32_32x32x16_bf16 v[128:143], v[96:99], a[160:163], v[128:143]
    buffer_load_dwordx4 a[192:195], v3, s[8:11], s45 offen offset:2048 sc1
    v_mfma_f32_32x32x16_bf16 v[144:159], v[100:103], a[160:163], v[144:159]
    buffer_load_dword v32, v30, s[8:11], s61 offen offset:0 sc1
    buffer_load_dword v33, v30, s[8:11], s61 offen offset:256 sc1
    s_waitcnt vmcnt(10)
    v_mfma_f32_32x32x16_bf16 v[128:143], v[104:107], a[164:167], v[128:143]
    buffer_load_dwordx4 a[196:199], v3, s[8:11], s45 offen offset:3072 sc1
    v_mfma_f32_32x32x16_bf16 v[144:159], v[108:111], a[164:167], v[144:159]
    buffer_load_dword v34, v30, s[8:11], s61 offen offset:512 sc1
    buffer_load_dword v35, v30, s[8:11], s61 offen offset:768 sc1
    s_waitcnt vmcnt(12)
    v_mfma_f32_32x32x16_bf16 v[128:143], v[112:115], a[168:171], v[128:143]
    s_add_u32 s45, s45, 4096
    buffer_load_dwordx4 a[200:203], v3, s[8:11], s45 offen offset:0 sc1
    v_mfma_f32_32x32x16_bf16 v[144:159], v[116:119], a[168:171], v[144:159]
    buffer_load_dword v36, v30, s[8:11], s61 offen offset:1024 sc1
    buffer_load_dword v37, v30, s[8:11], s61 offen offset:1280 sc1
    s_waitcnt vmcnt(14)
    v_mfma_f32_32x32x16_bf16 v[128:143], v[120:123], a[172:175], v[128:143]
    buffer_load_dwordx4 a[204:207], v3, s[8:11], s45 offen offset:1024 sc1
    v_mfma_f32_32x32x16_bf16 v[144:159], v[124:127], a[172:175], v[144:159]
    buffer_load_dword v38, v30, s[8:11], s61 offen offset:1536 sc1
    s_waitcnt vmcnt(15)
    v_mfma_f32_32x32x16_bf16 v[128:143], a[0:3], a[176:179], v[128:143]
    buffer_load_dwordx4 a[208:211], v3, s[8:11], s45 offen offset:2048 sc1
    v_mfma_f32_32x32x16_bf16 v[144:159], a[4:7], a[176:179], v[144:159]
    buffer_load_dword v31, v0, s[8:11], s33 offen offset:512 sc1
    s_waitcnt vmcnt(16)
    v_mfma_f32_32x32x16_bf16 v[128:143], a[8:11], a[180:183], v[128:143]
    s_add_u32 s45, s22, 3
    s_and_b32 s45, s45, 3
    s_mul_i32 s45, s45, 7168
    s_add_u32 s45, s45, s37
    buffer_load_dwordx4 a[212:215], v3, s[8:11], s45 offen offset:0 sc1
    v_mfma_f32_32x32x16_bf16 v[144:159], a[12:15], a[180:183], v[144:159]
    s_waitcnt vmcnt(16)
    v_mfma_f32_32x32x16_bf16 v[128:143], a[16:19], a[184:187], v[128:143]
    buffer_load_dwordx4 a[216:219], v3, s[8:11], s45 offen offset:1024 sc1
    v_mfma_f32_32x32x16_bf16 v[144:159], a[20:23], a[184:187], v[144:159]
    s_waitcnt vmcnt(16)
    v_mfma_f32_32x32x16_bf16 v[128:143], a[24:27], a[188:191], v[128:143]
    buffer_load_dwordx4 a[220:223], v3, s[8:11], s45 offen offset:2048 sc1
    v_mfma_f32_32x32x16_bf16 v[144:159], a[28:31], a[188:191], v[144:159]
    s_waitcnt vmcnt(15)
    v_mfma_f32_32x32x16_bf16 v[128:143], a[32:35], a[192:195], v[128:143]
    buffer_load_dwordx4 a[128:131], v3, s[8:11], s45 offen offset:3072 sc1
    v_mfma_f32_32x32x16_bf16 v[144:159], a[36:39], a[192:195], v[144:159]
    s_waitcnt vmcnt(4)
    v_cmp_eq_u32 vcc, 0, v31
    s_mov_b32 s50, 262144
    s_cbranch_vccnz L_se_poll_33
L_se_done_34:
    v_mfma_f32_32x32x16_bf16 v[128:143], a[40:43], a[196:199], v[128:143]
    s_add_u32 s45, s45, 4096
    buffer_load_dwordx4 a[132:135], v3, s[8:11], s45 offen offset:0 sc1
    v_mfma_f32_32x32x16_bf16 v[144:159], a[44:47], a[196:199], v[144:159]
    v_mfma_f32_32x32x16_bf16 v[128:143], a[48:51], a[200:203], v[128:143]
    buffer_load_dwordx4 a[136:139], v3, s[8:11], s45 offen offset:1024 sc1
    v_mfma_f32_32x32x16_bf16 v[144:159], a[52:55], a[200:203], v[144:159]
    v_mfma_f32_32x32x16_bf16 v[128:143], a[56:59], a[204:207], v[128:143]
    buffer_load_dwordx4 a[140:143], v3, s[8:11], s45 offen offset:2048 sc1
    v_mfma_f32_32x32x16_bf16 v[144:159], a[60:63], a[204:207], v[144:159]
    v_mfma_f32_32x32x16_bf16 v[128:143], a[64:67], a[208:211], v[128:143]
    s_cmp_eq_u32 s23, 0
    s_movk_i32 s58, 1024
    s_cselect_b32 s57, 0x4000, s58
    s_cselect_b32 s59, s55, s56
    s_cselect_b64 vcc, -1, 0
    s_mul_i32 s58, s20, 28
    s_mul_i32 s58, s58, s57
    s_add_u32 s59, s59, s58
    v_cndmask_b32 v25, v3, v11, vcc
    s_mul_i32 s58, s57, 7
    s_add_u32 s45, s22, 0
    s_and_b32 s45, s45, 3
    s_mul_i32 s45, s45, s58
    s_add_u32 s45, s45, s59
    buffer_load_dwordx4 a[144:147], v25, s[8:11], s45 offen sc1
    v_mfma_f32_32x32x16_bf16 v[144:159], a[68:71], a[208:211], v[144:159]
    s_waitcnt vmcnt(7)
    v_mfma_f32_32x32x16_bf16 v[128:143], a[72:75], a[212:215], v[128:143]
    s_add_u32 s45, s45, s57
    buffer_load_dwordx4 a[148:151], v25, s[8:11], s45 offen sc1
    v_mfma_f32_32x32x16_bf16 v[144:159], a[76:79], a[212:215], v[144:159]
    s_waitcnt vmcnt(7)
    v_mfma_f32_32x32x16_bf16 v[128:143], a[80:83], a[216:219], v[128:143]
    s_add_u32 s45, s45, s57
    buffer_load_dwordx4 a[152:155], v25, s[8:11], s45 offen sc1
    v_mfma_f32_32x32x16_bf16 v[144:159], a[84:87], a[216:219], v[144:159]
    v_add_f32 v32, v32, v33
    v_add_f32 v34, v34, v35
    v_add_f32 v36, v36, v37
    v_add_f32 v32, v32, v38
    s_waitcnt vmcnt(7)
    v_mfma_f32_32x32x16_bf16 v[128:143], a[88:91], a[220:223], v[128:143]
    s_add_u32 s45, s45, s57
    buffer_load_dwordx4 a[156:159], v25, s[8:11], s45 offen sc1
    v_mfma_f32_32x32x16_bf16 v[144:159], a[92:95], a[220:223], v[144:159]
    v_add_f32 v34, v34, v36
    v_mov_b32 v33, 0x3727c5ac
    v_add_f32 v32, v32, v34
    v_fmac_f32 v33, 0x3b124925, v32
    s_waitcnt vmcnt(7)
    v_mfma_f32_32x32x16_bf16 v[128:143], a[96:99], a[128:131], v[128:143]
    s_add_u32 s45, s45, s57
    buffer_load_dwordx4 a[160:163], v25, s[8:11], s45 offen sc1
    v_mfma_f32_32x32x16_bf16 v[144:159], a[100:103], a[128:131], v[144:159]
    v_rcp_f32 v32, v33
    v_add_u32 v29, 128, v28
    s_waitcnt vmcnt(7)
    v_mfma_f32_32x32x16_bf16 v[128:143], a[104:107], a[132:135], v[128:143]
    s_add_u32 s45, s45, s57
    buffer_load_dwordx4 a[164:167], v25, s[8:11], s45 offen sc1
    v_mfma_f32_32x32x16_bf16 v[144:159], a[108:111], a[132:135], v[144:159]
    ds_bpermute_b32 v22, v28, v32
    ds_bpermute_b32 v23, v29, v32
    s_waitcnt vmcnt(7)
    v_mfma_f32_32x32x16_bf16 v[128:143], a[112:115], a[136:139], v[128:143]
    s_add_u32 s45, s45, s57
    buffer_load_dwordx4 a[168:171], v25, s[8:11], s45 offen sc1
    v_mfma_f32_32x32x16_bf16 v[144:159], a[116:119], a[136:139], v[144:159]
    s_waitcnt vmcnt(7)
    v_mfma_f32_32x32x16_bf16 v[128:143], a[120:123], a[140:143], v[128:143]
    s_add_u32 s45, s22, 1
    s_and_b32 s45, s45, 3
    s_mul_i32 s45, s45, s58
    s_add_u32 s45, s45, s59
    buffer_load_dwordx4 a[172:175], v25, s[8:11], s45 offen sc1
    v_mfma_f32_32x32x16_bf16 v[144:159], a[124:127], a[140:143], v[144:159]
    s_waitcnt vmcnt(7)
    v_mfma_f32_32x32x16_bf16 v[160:175], a[224:227], a[144:147], 0
    s_add_u32 s45, s45, s57
    buffer_load_dwordx4 a[176:179], v25, s[8:11], s45 offen sc1
    v_mfma_f32_32x32x16_bf16 v[176:191], a[228:231], a[144:147], 0
    s_waitcnt vmcnt(7)
    v_mfma_f32_32x32x16_bf16 v[160:175], a[232:235], a[148:151], v[160:175]
    s_add_u32 s45, s45, s57
    buffer_load_dwordx4 a[180:183], v25, s[8:11], s45 offen sc1
    v_mfma_f32_32x32x16_bf16 v[176:191], a[236:239], a[148:151], v[176:191]
    ds_write_b128 v12, v[128:131] offset:0
    s_waitcnt vmcnt(7)
    v_mfma_f32_32x32x16_bf16 v[160:175], a[240:243], a[152:155], v[160:175]
    s_add_u32 s45, s45, s57
    buffer_load_dwordx4 a[184:187], v25, s[8:11], s45 offen sc1
    v_mfma_f32_32x32x16_bf16 v[176:191], a[244:247], a[152:155], v[176:191]
    ds_write_b128 v13, v[132:135] offset:0
    s_waitcnt vmcnt(7)
    v_mfma_f32_32x32x16_bf16 v[160:175], a[248:251], a[156:159], v[160:175]
    s_add_u32 s45, s45, s57
    buffer_load_dwordx4 a[188:191], v25, s[8:11], s45 offen sc1
    v_mfma_f32_32x32x16_bf16 v[176:191], a[252:255], a[156:159], v[176:191]
    ds_write_b128 v14, v[136:139] offset:0
    s_waitcnt vmcnt(7)
    v_mfma_f32_32x32x16_bf16 v[160:175], v[64:67], a[160:163], v[160:175]
    s_add_u32 s45, s45, s57
    buffer_load_dwordx4 a[192:195], v25, s[8:11], s45 offen sc1
    v_mfma_f32_32x32x16_bf16 v[176:191], v[68:71], a[160:163], v[176:191]
    ds_write_b128 v15, v[140:143] offset:0
    s_waitcnt vmcnt(7)
    v_mfma_f32_32x32x16_bf16 v[160:175], v[72:75], a[164:167], v[160:175]
    s_add_u32 s45, s45, s57
    buffer_load_dwordx4 a[196:199], v25, s[8:11], s45 offen sc1
    v_mfma_f32_32x32x16_bf16 v[176:191], v[76:79], a[164:167], v[176:191]
    ds_write_b128 v16, v[144:147] offset:0
    s_waitcnt vmcnt(7)
    v_mfma_f32_32x32x16_bf16 v[160:175], v[80:83], a[168:171], v[160:175]
    s_add_u32 s45, s22, 2
    s_and_b32 s45, s45, 3
    s_mul_i32 s45, s45, s58
    s_add_u32 s45, s45, s59
    buffer_load_dwordx4 a[200:203], v25, s[8:11], s45 offen sc1
    v_mfma_f32_32x32x16_bf16 v[176:191], v[84:87], a[168:171], v[176:191]
    ds_write_b128 v17, v[148:151] offset:0
    s_waitcnt vmcnt(7)
    v_mfma_f32_32x32x16_bf16 v[160:175], v[88:91], a[172:175], v[160:175]
    s_add_u32 s45, s45, s57
    buffer_load_dwordx4 a[204:207], v25, s[8:11], s45 offen sc1
    v_mfma_f32_32x32x16_bf16 v[176:191], v[92:95], a[172:175], v[176:191]
    ds_write_b128 v18, v[152:155] offset:0
    s_waitcnt vmcnt(7)
    v_mfma_f32_32x32x16_bf16 v[160:175], v[96:99], a[176:179], v[160:175]
    s_add_u32 s45, s45, s57
    buffer_load_dwordx4 a[208:211], v25, s[8:11], s45 offen sc1
    v_mfma_f32_32x32x16_bf16 v[176:191], v[100:103], a[176:179], v[176:191]
    ds_write_b128 v19, v[156:159] offset:0
    s_waitcnt vmcnt(7)
    v_mfma_f32_32x32x16_bf16 v[160:175], v[104:107], a[180:183], v[160:175]
    s_add_u32 s45, s45, s57
    buffer_load_dwordx4 a[212:215], v25, s[8:11], s45 offen sc1
    v_mfma_f32_32x32x16_bf16 v[176:191], v[108:111], a[180:183], v[176:191]
    ds_read_b128 v[224:227], v24 offset:0
    s_waitcnt vmcnt(7)
    v_mfma_f32_32x32x16_bf16 v[160:175], v[112:115], a[184:187], v[160:175]
    s_add_u32 s45, s45, s57
    buffer_load_dwordx4 a[216:219], v25, s[8:11], s45 offen sc1
    v_mfma_f32_32x32x16_bf16 v[176:191], v[116:119], a[184:187], v[176:191]
    s_waitcnt lgkmcnt(0)
    s_barrier
    ds_read_b128 v[192:195], v20 offset:0
    ds_read_b128 v[196:199], v21 offset:0
    s_waitcnt vmcnt(7)
    v_mfma_f32_32x32x16_bf16 v[160:175], v[120:123], a[188:191], v[160:175]
    s_add_u32 s45, s45, s57
    buffer_load_dwordx4 a[220:223], v25, s[8:11], s45 offen sc1
    v_mfma_f32_32x32x16_bf16 v[176:191], v[124:127], a[188:191], v[176:191]
    ds_read_b128 v[200:203], v20 offset:8192
    ds_read_b128 v[204:207], v21 offset:8192
    s_waitcnt vmcnt(7)
    v_mfma_f32_32x32x16_bf16 v[160:175], a[0:3], a[192:195], v[160:175]
    s_add_u32 s45, s45, s57
    buffer_load_dwordx4 a[128:131], v25, s[8:11], s45 offen sc1
    v_mfma_f32_32x32x16_bf16 v[176:191], a[4:7], a[192:195], v[176:191]
    ds_read_b128 v[208:211], v20 offset:16384
    ds_read_b128 v[212:215], v21 offset:16384
    s_waitcnt vmcnt(7)
    v_mfma_f32_32x32x16_bf16 v[160:175], a[8:11], a[196:199], v[160:175]
    s_add_u32 s45, s22, 3
    s_and_b32 s45, s45, 3
    s_mul_i32 s45, s45, s58
    s_add_u32 s45, s45, s59
    buffer_load_dwordx4 a[132:135], v25, s[8:11], s45 offen sc1
    v_mfma_f32_32x32x16_bf16 v[176:191], a[12:15], a[196:199], v[176:191]
    ds_read_b128 v[216:219], v20 offset:24576
    ds_read_b128 v[220:223], v21 offset:24576
    s_waitcnt vmcnt(7)
    v_mfma_f32_32x32x16_bf16 v[160:175], a[16:19], a[200:203], v[160:175]
    s_add_u32 s45, s45, s57
    buffer_load_dwordx4 a[136:139], v25, s[8:11], s45 offen sc1
    v_mfma_f32_32x32x16_bf16 v[176:191], a[20:23], a[200:203], v[176:191]
    v_lshlrev_b32 v228, 16, v224
    v_and_b32 v229, 0xffff0000, v224
    v_lshlrev_b32 v230, 16, v225
    v_and_b32 v231, 0xffff0000, v225
    s_waitcnt vmcnt(7)
    v_mfma_f32_32x32x16_bf16 v[160:175], a[24:27], a[204:207], v[160:175]
    s_add_u32 s45, s45, s57
    buffer_load_dwordx4 a[140:143], v25, s[8:11], s45 offen sc1
    v_mfma_f32_32x32x16_bf16 v[176:191], a[28:31], a[204:207], v[176:191]
    v_lshlrev_b32 v232, 16, v226
    v_and_b32 v233, 0xffff0000, v226
    v_lshlrev_b32 v234, 16, v227
    v_and_b32 v235, 0xffff0000, v227
    s_add_u32 s26, s39, 16384
    buffer_store_dword v2, off, s[8:11], s26 sc1
    s_waitcnt vmcnt(8)
    v_mfma_f32_32x32x16_bf16 v[160:175], a[32:35], a[208:211], v[160:175]
    s_add_u32 s45, s45, s57
    buffer_load_dwordx4 a[144:147], v25, s[8:11], s45 offen sc1
    v_mfma_f32_32x32x16_bf16 v[176:191], a[36:39], a[208:211], v[176:191]
    s_waitcnt lgkmcnt(4)
    v_add_f32 v192, v192, v200
    v_add_f32 v193, v193, v201
    v_add_f32 v194, v194, v202
    v_add_f32 v195, v195, v203
    s_waitcnt vmcnt(8)
    v_mfma_f32_32x32x16_bf16 v[160:175], a[40:43], a[212:215], v[160:175]
    s_add_u32 s45, s45, s57
    buffer_load_dwordx4 a[148:151], v25, s[8:11], s45 offen sc1
    v_mfma_f32_32x32x16_bf16 v[176:191], a[44:47], a[212:215], v[176:191]
    v_add_f32 v196, v196, v204
    v_add_f32 v197, v197, v205
    v_add_f32 v198, v198, v206
    v_add_f32 v199, v199, v207
    s_waitcnt vmcnt(8)
    v_mfma_f32_32x32x16_bf16 v[160:175], a[48:51], a[216:219], v[160:175]
    s_add_u32 s45, s45, s57
    buffer_load_dwordx4 a[152:155], v25, s[8:11], s45 offen sc1
    v_mfma_f32_32x32x16_bf16 v[176:191], a[52:55], a[216:219], v[176:191]
    s_waitcnt lgkmcnt(0)
    v_add_f32 v208, v208, v216
    v_add_f32 v209, v209, v217
    v_add_f32 v210, v210, v218
    v_add_f32 v211, v211, v219
    s_waitcnt vmcnt(8)
    v_mfma_f32_32x32x16_bf16 v[160:175], a[56:59], a[220:223], v[160:175]
    s_add_u32 s45, s45, s57
    buffer_load_dwordx4 a[156:159], v25, s[8:11], s45 offen sc1
    v_mfma_f32_32x32x16_bf16 v[176:191], a[60:63], a[220:223], v[176:191]
    v_add_f32 v212, v212, v220
    v_add_f32 v213, v213, v221
    v_add_f32 v214, v214, v222
    v_add_f32 v215, v215, v223
    s_waitcnt vmcnt(8)
    v_mfma_f32_32x32x16_bf16 v[160:175], a[64:67], a[128:131], v[160:175]
    v_add_f32 v192, v192, v208
    v_add_f32 v193, v193, v209
    v_add_f32 v194, v194, v210
    v_add_f32 v195, v195, v211
    v_mfma_f32_32x32x16_bf16 v[176:191], a[68:71], a[128:131], v[176:191]
    v_add_f32 v196, v196, v212
    v_add_f32 v197, v197, v213
    v_add_f32 v198, v198, v214
    v_add_f32 v199, v199, v215
    s_waitcnt vmcnt(7)
    v_mfma_f32_32x32x16_bf16 v[160:175], a[72:75], a[132:135], v[160:175]
    v_fmac_f32 v228, v192, v22
    v_fmac_f32 v229, v193, v22
    v_fmac_f32 v230, v194, v22
    v_fmac_f32 v231, v195, v22
    v_mfma_f32_32x32x16_bf16 v[176:191], a[76:79], a[132:135], v[176:191]
    v_fmac_f32 v232, v196, v22
    v_fmac_f32 v233, v197, v22
    v_fmac_f32 v234, v198, v22
    v_fmac_f32 v235, v199, v22
    s_waitcnt vmcnt(6)
    v_mfma_f32_32x32x16_bf16 v[160:175], a[80:83], a[136:139], v[160:175]
    v_cvt_pk_bf16_f32 v200, v228, v229
    v_cvt_pk_bf16_f32 v201, v230, v231
    v_cvt_pk_bf16_f32 v202, v232, v233
    v_cvt_pk_bf16_f32 v203, v234, v235
    v_mfma_f32_32x32x16_bf16 v[176:191], a[84:87], a[136:139], v[176:191]
    buffer_store_dwordx4 v[200:203], v10, s[16:19], s30 offen sc1
    s_waitcnt vmcnt(6)
    v_mfma_f32_32x32x16_bf16 v[160:175], a[88:91], a[140:143], v[160:175]
    v_mfma_f32_32x32x16_bf16 v[176:191], a[92:95], a[140:143], v[176:191]
    s_waitcnt vmcnt(4)
    v_mfma_f32_32x32x16_bf16 v[160:175], a[96:99], a[144:147], v[160:175]
    v_mfma_f32_32x32x16_bf16 v[176:191], a[100:103], a[144:147], v[176:191]
    s_waitcnt vmcnt(3)
    v_mfma_f32_32x32x16_bf16 v[160:175], a[104:107], a[148:151], v[160:175]
    v_mfma_f32_32x32x16_bf16 v[176:191], a[108:111], a[148:151], v[176:191]
    s_waitcnt vmcnt(2)
    v_mfma_f32_32x32x16_bf16 v[160:175], a[112:115], a[152:155], v[160:175]
    v_mfma_f32_32x32x16_bf16 v[176:191], a[116:119], a[152:155], v[176:191]
    s_waitcnt vmcnt(1)
    v_mfma_f32_32x32x16_bf16 v[160:175], a[120:123], a[156:159], v[160:175]
    v_mfma_f32_32x32x16_bf16 v[176:191], a[124:127], a[156:159], v[176:191]
    ds_read_b128 v[224:227], v24 offset:4096
    s_nop 9
    ds_write_b128 v12, v[160:163] offset:32768
    ds_write_b128 v13, v[164:167] offset:32768
    ds_write_b128 v14, v[168:171] offset:32768
    ds_write_b128 v15, v[172:175] offset:32768
    ds_write_b128 v16, v[176:179] offset:32768
    ds_write_b128 v17, v[180:183] offset:32768
    ds_write_b128 v18, v[184:187] offset:32768
    ds_write_b128 v19, v[188:191] offset:32768
    s_waitcnt lgkmcnt(0)
    s_barrier
    ds_read_b128 v[192:195], v20 offset:32768
    ds_read_b128 v[196:199], v21 offset:32768
    ds_read_b128 v[200:203], v20 offset:40960
    ds_read_b128 v[204:207], v21 offset:40960
    ds_read_b128 v[208:211], v20 offset:49152
    ds_read_b128 v[212:215], v21 offset:49152
    ds_read_b128 v[216:219], v20 offset:57344
    ds_read_b128 v[220:223], v21 offset:57344
    v_lshlrev_b32 v228, 16, v224
    v_and_b32 v229, 0xffff0000, v224
    v_lshlrev_b32 v230, 16, v225
    v_and_b32 v231, 0xffff0000, v225
    v_lshlrev_b32 v232, 16, v226
    v_and_b32 v233, 0xffff0000, v226
    v_lshlrev_b32 v234, 16, v227
    v_and_b32 v235, 0xffff0000, v227
    s_waitcnt lgkmcnt(4)
    v_pk_add_f32 v[192:193], v[192:193], v[200:201]
    v_pk_add_f32 v[194:195], v[194:195], v[202:203]
    v_pk_add_f32 v[196:197], v[196:197], v[204:205]
    v_pk_add_f32 v[198:199], v[198:199], v[206:207]
    s_waitcnt lgkmcnt(0)
    v_pk_add_f32 v[208:209], v[208:209], v[216:217]
    v_pk_add_f32 v[210:211], v[210:211], v[218:219]
    v_pk_add_f32 v[212:213], v[212:213], v[220:221]
    v_pk_add_f32 v[214:215], v[214:215], v[222:223]
    v_pk_add_f32 v[192:193], v[192:193], v[208:209]
    v_pk_add_f32 v[194:195], v[194:195], v[210:211]
    v_pk_add_f32 v[196:197], v[196:197], v[212:213]
    v_pk_add_f32 v[198:199], v[198:199], v[214:215]
    v_pk_fma_f32 v[228:229], v[192:193], v[22:23], v[228:229] op_sel:[0,1,0]
    v_pk_fma_f32 v[230:231], v[194:195], v[22:23], v[230:231] op_sel:[0,1,0]
    v_pk_fma_f32 v[232:233], v[196:197], v[22:23], v[232:233] op_sel:[0,1,0]
    v_pk_fma_f32 v[234:235], v[198:199], v[22:23], v[234:235] op_sel:[0,1,0]
    v_cvt_pk_bf16_f32 v200, v228, v229
    v_cvt_pk_bf16_f32 v201, v230, v231
    v_cvt_pk_bf16_f32 v202, v232, v233
    v_cvt_pk_bf16_f32 v203, v234, v235
    buffer_store_dwordx4 v[200:203], v10, s[16:19], s31 offen sc1
    s_endpgm
L_se_poll_29:
    buffer_load_dword v31, v0, s[8:11], s33 offen offset:0 sc1
    s_sub_u32 s50, s50, 1
    s_waitcnt vmcnt(0)
    s_cmp_eq_u32 s50, 0
    s_cbranch_scc1 L_se_done_30
    v_cmp_eq_u32 vcc, 0, v31
    s_nop 0
    s_cbranch_vccnz L_se_poll_29
    s_branch L_se_done_30
L_se_poll_31:
    buffer_load_dword v31, v0, s[8:11], s33 offen offset:256 sc1
    s_sub_u32 s50, s50, 1
    s_waitcnt vmcnt(0)
    s_cmp_eq_u32 s50, 0
    s_cbranch_scc1 L_se_done_32
    v_cmp_eq_u32 vcc, 0, v31
    s_nop 0
    s_cbranch_vccnz L_se_poll_31
    s_branch L_se_done_32
L_se_poll_33:
    buffer_load_dword v31, v0, s[8:11], s33 offen offset:512 sc1
    s_sub_u32 s50, s50, 1
    s_waitcnt vmcnt(0)
    s_cmp_eq_u32 s50, 0
    s_cbranch_scc1 L_se_done_34
    v_cmp_eq_u32 vcc, 0, v31
    s_nop 0
    s_cbranch_vccnz L_se_poll_33
    s_branch L_se_done_34
.section .rodata,"a"
.p2align 6
.amdhsa_kernel sequential_preLN__spectral_gfnet__glu_gated_bilinear__prompt_kernel
  .amdhsa_next_free_vgpr 512
  .amdhsa_next_free_sgpr 64
  .amdhsa_accum_offset 256
  .amdhsa_group_segment_fixed_size 0
  .amdhsa_kernarg_size 80
  .amdhsa_user_sgpr_count 2
  .amdhsa_user_sgpr_kernarg_segment_ptr 1
  .amdhsa_system_sgpr_workgroup_id_x 1
  .amdhsa_float_denorm_mode_32 3
.end_amdhsa_kernel
```
